```python
import torch

def _softmax(x, axis=-1):
    return torch.softmax(x, dim=axis)
def _gelu(x):
    return torch.nn.functional.gelu(x, approximate="tanh")
def _silu(x):
    return torch.nn.functional.silu(x)
def _sigmoid(x):
    return torch.sigmoid(x)
def _layernorm(x, axis=-1, eps=1e-5):
    m = x.mean(dim=axis, keepdim=True)
    v = x.var(dim=axis, keepdim=True, unbiased=False)
    return (x - m) / torch.sqrt(v + eps)
def _scatter_add(tgt, idx, src, axis=0):
    return tgt.clone().index_add_(axis, idx, src)
def _segment_sum(src, seg, n):
    out = torch.zeros((n,) + src.shape[1:], dtype=src.dtype)
    return out.index_add_(0, seg, src)
def _pad(x, pw):
    flat = tuple(v for pair in reversed(pw) for v in pair)
    return torch.nn.functional.pad(x, flat)

kernel_name = 'gather_scatter__edge_featured_mpnn_mpnn__graph'

def setup_inputs():

    _w = (lambda a: (lambda t: t.to(torch.bfloat16) if t.is_floating_point() else t)(torch.as_tensor(a)))
    N, deg, D, De = 12500, 32, 128, max(4, 1)
    E = N * deg
    H = 2 * D
    return {
        "x": _w((lambda *s: torch.randn(*s, dtype=torch.bfloat16) * 0.05)(N, D)),
        "e_attr": _w((lambda *s: torch.randn(*s, dtype=torch.bfloat16) * 1.6)(E, De)),
        "src": _w((lambda lo, hi, *s: torch.randint(lo, hi, s))(0, N, E).to(torch.int64)),
        "dst": _w((lambda lo, hi, *s: torch.randint(lo, hi, s))(0, N, E).to(torch.int64)),
        "w1": _w((lambda *s: torch.randn(*s, dtype=torch.bfloat16) * 1.6)(2 * D + De, H) * (1.0 / (2 * D + De) ** 0.5)),
        "b1": _w((lambda *s: torch.randn(*s, dtype=torch.bfloat16) * 3.2)(H) * 0.01),
        "w2": _w((lambda *s: torch.randn(*s, dtype=torch.bfloat16) * 0.05)(H, D) * (1.0 / H ** 0.5)),
        "b2": _w((lambda *s: torch.randn(*s, dtype=torch.bfloat16) * 0.1)(D) * 0.01),
    }

def reference(x, e_attr, src, dst, w1, b1, w2, b2):
    N, D = x.shape
    h_src = x[src]
    h_dst = x[dst]
    m_in = torch.concatenate([h_src, h_dst, e_attr], axis=-1)
    h = _silu(m_in @ w1 + b1)
    msg = h @ w2 + b2
    return _segment_sum(msg, dst, N)
```

```asm
; @launch kernel=k1_kernel grid=(256,1,1) block=(896,1,1) lds=145408
; @launch kernel=k2_kernel grid=(256,1,1) block=(1024,1,1) lds=156480
.amdgcn_target "amdgcn-amd-amdhsa--gfx950"
.text
.globl k1_kernel
.type k1_kernel,@function
.globl k2_kernel
.type k2_kernel,@function
.p2align 8
k1_kernel:
    s_load_dwordx16 s[16:31], s[0:1], 0
    s_load_dwordx2 s[32:33], s[0:1], 80
    s_cmp_ge_u32 s2, 125
    s_cbranch_scc1 K1_G0
    v_lshrrev_b32 v2, 6, v0
    v_and_b32 v1, 63, v0
    v_lshlrev_b32 v8, 2, v0
    v_readfirstlane_b32 s3, v2
    v_mov_b32 v9, 0
    ds_write_b32 v8, v9
    s_mov_b32 s39, 0x00020000
    s_mov_b32 s43, 0x00020000
    s_mov_b32 s47, 0x00020000
    s_cmp_lt_u32 s3, 13
    s_cbranch_scc1 K1_PGO

    s_cmp_gt_u32 s2, 16
    s_cbranch_scc1 K1_PEX
    s_barrier
    s_branch K1_PREP

K1_PEX:
    s_endpgm
K1_PGO:
    s_mul_i32 s5, s2, 12800
    s_add_u32 s6, s5, 6400
    s_lshl_b32 s7, s5, 1
    s_lshl_b32 s8, s6, 1
    v_lshlrev_b32 v6, 3, v0
    v_lshlrev_b32 v7, 4, v0
    v_cmp_gt_u32 vcc, 800, v0
    s_mov_b64 s[14:15], vcc
    s_mov_b32 s38, 1600000
    s_mov_b32 s42, 1600000
    s_mov_b32 s46, 3200000
    s_mov_b32 s11, -49
    v_lshlrev_b32 v10, 4, v1
    s_waitcnt lgkmcnt(0)
    s_mov_b64 s[36:37], s[22:23]
    s_mov_b64 s[40:41], s[20:21]
    s_mov_b64 s[44:45], s[18:19]
    s_mov_b64 exec, s[14:15]
    buffer_load_dwordx2 v[16:17], v6, s[36:39], s5 offen nt
    buffer_load_dwordx2 v[18:19], v6, s[36:39], s6 offen nt
    v_mov_b32 v9, 1

    s_barrier
K1_PMAIN:
    s_mul_i32 s10, s2, 38400
    s_add_u32 s48, s32, 0x700000
    s_addc_u32 s49, s33, 0
    s_add_u32 s50, s10, 38400
    s_mov_b32 s51, 0x00020000

    s_add_u32 s52, s32, 0xc00000
    s_addc_u32 s53, s33, 0
    s_mov_b32 s54, 131072
    s_mov_b32 s55, 0x00020000
    s_waitcnt vmcnt(0)
    v_mul_u32_u24 v32, 21400, v16
    v_lshrrev_b32 v32, 20, v32
    v_mad_i32_i24 v16, v32, s11, v16
    v_lshlrev_b32 v32, 2, v32
    ds_add_rtn_u32 v36, v32, v9
    v_mul_u32_u24 v33, 21400, v17
    v_lshrrev_b32 v33, 20, v33
    v_mad_i32_i24 v17, v33, s11, v17
    v_lshlrev_b32 v33, 2, v33
    ds_add_rtn_u32 v37, v33, v9
    v_mul_u32_u24 v34, 21400, v18
    v_lshrrev_b32 v34, 20, v34
    v_mad_i32_i24 v18, v34, s11, v18
    v_lshlrev_b32 v34, 2, v34
    ds_add_rtn_u32 v38, v34, v9
    v_mul_u32_u24 v35, 21400, v19
    v_lshrrev_b32 v35, 20, v35
    v_mad_i32_i24 v19, v35, s11, v19
    v_lshlrev_b32 v35, 2, v35
    ds_add_rtn_u32 v39, v35, v9
    buffer_load_dwordx2 v[20:21], v6, s[40:43], s5 offen nt
    buffer_load_dwordx2 v[22:23], v6, s[40:43], s6 offen nt
    buffer_load_dwordx4 v[24:27], v7, s[44:47], s7 offen nt
    buffer_load_dwordx4 v[28:31], v7, s[44:47], s8 offen nt

    s_waitcnt lgkmcnt(0)
    s_barrier

    s_mov_b64 exec, -1
    ds_read_b128 v[80:83], v10
    v_mov_b32 v12, 8192

    s_waitcnt lgkmcnt(0)
    v_add_u32 v85, v80, v81
    v_add_u32 v86, v85, v82
    v_add_u32 v87, v86, v83
    v_mov_b32 v88, v87

    s_nop 1
    v_add_u32_dpp v88, v88, v88 row_shr:1 row_mask:0xf bank_mask:0xf bound_ctrl:0
    s_nop 1
    v_add_u32_dpp v88, v88, v88 row_shr:2 row_mask:0xf bank_mask:0xf bound_ctrl:0
    s_nop 1
    v_add_u32_dpp v88, v88, v88 row_shr:4 row_mask:0xf bank_mask:0xf bound_ctrl:0
    s_nop 1
    v_add_u32_dpp v88, v88, v88 row_shr:8 row_mask:0xf bank_mask:0xf bound_ctrl:0
    s_nop 1
    v_add_u32_dpp v88, v88, v88 row_bcast:15 row_mask:0xa bank_mask:0xf
    s_nop 1
    v_add_u32_dpp v88, v88, v88 row_bcast:31 row_mask:0xc bank_mask:0xf
    v_sub_u32 v84, v88, v87
    v_add_u32 v87, v84, v86
    v_add_u32 v86, v84, v85
    v_add_u32 v85, v84, v80
    ds_write_b128 v10, v[84:87] offset:4096

    s_mov_b64 exec, s[14:15]
    s_waitcnt lgkmcnt(0)

    ds_read_b32 v32, v32 offset:4096
    ds_read_b32 v33, v33 offset:4096
    ds_read_b32 v34, v34 offset:4096
    ds_read_b32 v35, v35 offset:4096
    s_waitcnt vmcnt(2)
    v_lshl_or_b32 v20, v16, 16, v20
    v_lshl_or_b32 v21, v17, 16, v21
    v_lshl_or_b32 v22, v18, 16, v22
    v_lshl_or_b32 v23, v19, 16, v23
    s_waitcnt lgkmcnt(3)
    v_add_u32 v32, v32, v36
    v_mad_u32_u24 v32, v32, 12, v12
    ds_write_b32 v32, v20 offset:8
    s_waitcnt lgkmcnt(3)
    v_add_u32 v33, v33, v37
    v_mad_u32_u24 v33, v33, 12, v12
    ds_write_b32 v33, v21 offset:8
    s_waitcnt lgkmcnt(3)
    v_add_u32 v34, v34, v38
    v_mad_u32_u24 v34, v34, 12, v12
    ds_write_b32 v34, v22 offset:8
    s_waitcnt lgkmcnt(3)
    v_add_u32 v35, v35, v39
    v_mad_u32_u24 v35, v35, 12, v12
    ds_write_b32 v35, v23 offset:8
    s_waitcnt vmcnt(1)
    ds_write2_b32 v32, v24, v25 offset0:0 offset1:1
    ds_write2_b32 v33, v26, v27 offset0:0 offset1:1
    s_waitcnt vmcnt(0)
    ds_write2_b32 v34, v28, v29 offset0:0 offset1:1
    ds_write2_b32 v35, v30, v31 offset0:0 offset1:1
    s_mov_b64 exec, -1

    s_cmp_lg_u32 s3, 12
    s_cbranch_scc1 K1_NOTBL
    v_lshl_or_b32 v80, v80, 16, v84
    v_lshl_or_b32 v81, v81, 16, v85
    v_lshl_or_b32 v82, v82, 16, v86
    v_lshl_or_b32 v83, v83, 16, v87
    s_lshl_b32 s9, s2, 10
    buffer_store_dwordx4 v[80:83], v10, s[52:55], s9 offen sc1

K1_NOTBL:
    s_waitcnt lgkmcnt(0)
    s_barrier

    ds_read_b128 v[16:19], v7 offset:8192
    ds_read_b128 v[20:23], v7 offset:21504
    ds_read_b128 v[24:27], v7 offset:34816
    s_waitcnt lgkmcnt(2)
    buffer_store_dwordx4 v[16:19], v7, s[48:51], s10 offen sc1
    s_add_u32 s10, s10, 13312
    s_waitcnt lgkmcnt(1)
    buffer_store_dwordx4 v[20:23], v7, s[48:51], s10 offen sc1
    s_add_u32 s10, s10, 13312
    s_waitcnt lgkmcnt(0)
    buffer_store_dwordx4 v[24:27], v7, s[48:51], s10 offen sc1
    s_add_u32 s10, s10, 13312
K1_END0:
    s_endpgm
.p2align 6
K1_G0:
    s_cmp_ge_u32 s2, 256
    s_cbranch_scc1 K1_ENDG
    v_lshrrev_b32 v2, 6, v0
    v_and_b32 v1, 63, v0
    v_and_b32 v3, 31, v0
    v_readfirstlane_b32 s3, v2
    v_lshrrev_b32 v4, 5, v1
    s_mov_b32 s39, 0x00020000
    s_mov_b32 s43, 0x00020000
    s_sub_u32 s34, s2, 125
    s_mov_b32 s38, 133120
    s_cmp_ge_u32 s3, 11
    s_cbranch_scc1 K1_G11
    s_max_u32 s11, s3, 3
    s_lshr_b32 s4, s2, 3
    s_add_u32 s4, s4, s11
    s_and_b32 s4, s4, 7
    s_lshl_b32 s4, s4, 13
    s_sub_u32 s11, s3, 1
    s_lshl_b32 s6, s11, 13
    s_mul_i32 s5, s34, 24576
    s_add_u32 s5, s5, s6
    s_add_u32 s6, s6, 65536
    s_cmp_lt_u32 s11, 3
    s_cselect_b32 s5, s5, s4
    s_cselect_b32 s6, s6, s4
    s_cselect_b32 s38, 3200000, s38
    s_cselect_b32 s7, 0x30, 0x20
    s_cselect_b32 s8, 0, 1
    s_cselect_b32 s9, 64, 128
    s_cselect_b32 s10, 128, 0
    v_lshlrev_b32 v10, 4, v1
    v_and_b32 v6, s7, v1
    v_lshlrev_b32 v6, s8, v6
    v_xor_b32 v6, v6, v10
    v_xor_b32 v7, s9, v6
    v_xor_b32 v8, s10, v6
    v_xor_b32 v9, s10, v7
    v_add_u32 v10, s6, v10
    s_add_u32 s4, s5, 4096
    s_cmp_lt_u32 s11, 3
    s_waitcnt lgkmcnt(0)
    s_cselect_b64 s[36:37], s[16:17], s[24:25]

    buffer_load_dwordx4 v[16:19], v6, s[36:39], s5 offen offset:0
    buffer_load_dwordx4 v[20:23], v7, s[36:39], s5 offen offset:1024
    buffer_load_dwordx4 v[24:27], v8, s[36:39], s5 offen offset:2048
    buffer_load_dwordx4 v[28:31], v9, s[36:39], s5 offen offset:3072
    buffer_load_dwordx4 v[32:35], v6, s[36:39], s4 offen offset:0
    buffer_load_dwordx4 v[36:39], v7, s[36:39], s4 offen offset:1024
    buffer_load_dwordx4 v[40:43], v8, s[36:39], s4 offen offset:2048
    buffer_load_dwordx4 v[44:47], v9, s[36:39], s4 offen offset:3072
    s_branch K1_GW
K1_G11:
    s_waitcnt lgkmcnt(0)
    s_cmp_eq_u32 s3, 11
    s_cbranch_scc1 K1_GEMM

K1_ENDG:
    s_endpgm
K1_GW:
    s_waitcnt vmcnt(7)
    ds_write_b128 v10, v[16:19] offset:0
    s_waitcnt vmcnt(6)
    ds_write_b128 v10, v[20:23] offset:1024
    s_waitcnt vmcnt(5)
    ds_write_b128 v10, v[24:27] offset:2048
    s_waitcnt vmcnt(4)
    ds_write_b128 v10, v[28:31] offset:3072
    s_waitcnt vmcnt(3)
    ds_write_b128 v10, v[32:35] offset:4096
    s_waitcnt vmcnt(2)
    ds_write_b128 v10, v[36:39] offset:5120
    s_waitcnt vmcnt(1)
    ds_write_b128 v10, v[40:43] offset:6144
    s_waitcnt vmcnt(0)
    ds_write_b128 v10, v[44:47] offset:7168
K1_GEMM:
    s_mov_b32 s44, s32
    s_mov_b32 s45, s33
    s_mov_b32 s46, 6400000
    s_mov_b32 s47, 0x00020000
    s_mov_b32 s9, 0x07060302
    s_mov_b32 s10, 0xbfb8aa3b
    s_and_b32 s12, s3, 3
    s_lshr_b32 s13, s3, 2
    v_bfe_u32 v13, v1, 2, 2
    v_and_b32 v14, 1, v1
    v_bfe_u32 v15, v1, 4, 1
    v_lshl_or_b32 v10, v14, 1, v15
    s_lshl_b32 s14, s12, 3
    v_or_b32 v10, s14, v10
    v_lshlrev_b32 v14, 2, v13
    v_xor_b32 v10, v10, v14
    v_lshlrev_b32 v10, 4, v10
    v_bfe_u32 v14, v1, 1, 1
    v_lshl_add_u32 v10, v14, 3, v10
    v_lshl_add_u32 v10, v13, 9, v10
    v_lshl_add_u32 v10, v4, 12, v10
    v_xor_b32 v11, 64, v10
    v_and_b32 v12, 15, v3
    v_xor_b32 v12, v12, v4
    v_lshlrev_b32 v12, 4, v12
    v_lshl_add_u32 v12, v3, 8, v12
    s_lshl_b32 s14, s13, 13
    s_add_u32 s14, s14, 65536
    v_add_u32 v12, s14, v12
    s_mul_i32 s14, s3, 4608
    s_add_u32 s14, s14, 90112
    v_mul_u32_u24 v5, 144, v3
    v_lshl_add_u32 v5, v4, 5, v5
    v_add_u32 v5, s14, v5
    v_lshrrev_b32 v7, 3, v1
    v_and_b32 v8, 7, v1
    v_mul_u32_u24 v6, 144, v7
    v_lshl_add_u32 v6, v8, 4, v6
    v_add_u32 v6, s14, v6
    v_lshlrev_b32 v7, 9, v7
    v_lshl_add_u32 v7, v8, 4, v7
    s_mul_i32 s4, s34, 49152
    s_lshl_b32 s5, s13, 14
    s_add_u32 s4, s4, s5
    s_lshl_b32 s5, s12, 7
    s_add_u32 s4, s4, s5
    s_add_u32 s5, s4, 4096
    s_add_u32 s6, s4, 8192
    s_add_u32 s7, s4, 12288
    s_mov_b32 s15, 0x8000
    s_waitcnt vmcnt(0) lgkmcnt(0)

    s_barrier

    ds_read_b64_tr_b16 v[16:17], v10 offset:0
    ds_read_b64_tr_b16 v[18:19], v10 offset:2048
    ds_read_b64_tr_b16 v[20:21], v11 offset:0
    ds_read_b64_tr_b16 v[22:23], v11 offset:2048
    ds_read_b128 v[24:27], v12
    ds_read_b64_tr_b16 v[28:29], v10 offset:8192
    ds_read_b64_tr_b16 v[30:31], v10 offset:10240
    ds_read_b64_tr_b16 v[32:33], v11 offset:8192
    ds_read_b64_tr_b16 v[34:35], v11 offset:10240
    v_xor_b32 v9, 32, v12
    ds_read_b128 v[36:39], v9
    ds_read_b64_tr_b16 v[40:41], v10 offset:16384
    ds_read_b64_tr_b16 v[42:43], v10 offset:18432
    ds_read_b64_tr_b16 v[44:45], v11 offset:16384
    ds_read_b64_tr_b16 v[46:47], v11 offset:18432
    v_xor_b32 v9, 64, v12
    ds_read_b128 v[48:51], v9
    s_waitcnt lgkmcnt(10)
    v_mfma_f32_32x32x16_bf16 v[96:111], v[16:19], v[24:27], 0
    v_mfma_f32_32x32x16_bf16 v[112:127], v[20:23], v[24:27], 0
    ds_read_b64_tr_b16 v[52:53], v10 offset:24576
    ds_read_b64_tr_b16 v[54:55], v10 offset:26624
    ds_read_b64_tr_b16 v[56:57], v11 offset:24576
    ds_read_b64_tr_b16 v[58:59], v11 offset:26624
    v_xor_b32 v9, 96, v12
    ds_read_b128 v[60:63], v9
    s_waitcnt lgkmcnt(10)
    v_mfma_f32_32x32x16_bf16 v[96:111], v[28:31], v[36:39], v[96:111]
    v_mfma_f32_32x32x16_bf16 v[112:127], v[32:35], v[36:39], v[112:127]
    ds_read_b64_tr_b16 v[16:17], v10 offset:32768
    ds_read_b64_tr_b16 v[18:19], v10 offset:34816
    ds_read_b64_tr_b16 v[20:21], v11 offset:32768
    ds_read_b64_tr_b16 v[22:23], v11 offset:34816
    v_xor_b32 v9, 128, v12
    ds_read_b128 v[24:27], v9
    s_waitcnt lgkmcnt(10)
    v_mfma_f32_32x32x16_bf16 v[96:111], v[40:43], v[48:51], v[96:111]
    v_mfma_f32_32x32x16_bf16 v[112:127], v[44:47], v[48:51], v[112:127]
    ds_read_b64_tr_b16 v[28:29], v10 offset:40960
    ds_read_b64_tr_b16 v[30:31], v10 offset:43008
    ds_read_b64_tr_b16 v[32:33], v11 offset:40960
    ds_read_b64_tr_b16 v[34:35], v11 offset:43008
    v_xor_b32 v9, 160, v12
    ds_read_b128 v[36:39], v9
    s_waitcnt lgkmcnt(10)
    v_mfma_f32_32x32x16_bf16 v[96:111], v[52:55], v[60:63], v[96:111]
    v_mfma_f32_32x32x16_bf16 v[112:127], v[56:59], v[60:63], v[112:127]
    ds_read_b64_tr_b16 v[40:41], v10 offset:49152
    ds_read_b64_tr_b16 v[42:43], v10 offset:51200
    ds_read_b64_tr_b16 v[44:45], v11 offset:49152
    ds_read_b64_tr_b16 v[46:47], v11 offset:51200
    v_xor_b32 v9, 192, v12
    ds_read_b128 v[48:51], v9
    s_waitcnt lgkmcnt(10)
    v_mfma_f32_32x32x16_bf16 v[96:111], v[16:19], v[24:27], v[96:111]
    v_mfma_f32_32x32x16_bf16 v[112:127], v[20:23], v[24:27], v[112:127]
    ds_read_b64_tr_b16 v[52:53], v10 offset:57344
    ds_read_b64_tr_b16 v[54:55], v10 offset:59392
    ds_read_b64_tr_b16 v[56:57], v11 offset:57344
    ds_read_b64_tr_b16 v[58:59], v11 offset:59392
    v_xor_b32 v9, 224, v12
    ds_read_b128 v[60:63], v9
    s_waitcnt lgkmcnt(10)
    v_mfma_f32_32x32x16_bf16 v[96:111], v[28:31], v[36:39], v[96:111]
    v_mfma_f32_32x32x16_bf16 v[112:127], v[32:35], v[36:39], v[112:127]
    s_waitcnt lgkmcnt(5)
    v_mfma_f32_32x32x16_bf16 v[96:111], v[40:43], v[48:51], v[96:111]
    v_mfma_f32_32x32x16_bf16 v[112:127], v[44:47], v[48:51], v[112:127]
    s_waitcnt lgkmcnt(0)
    v_mfma_f32_32x32x16_bf16 v[96:111], v[52:55], v[60:63], v[96:111]
    v_mfma_f32_32x32x16_bf16 v[112:127], v[56:59], v[60:63], v[112:127]
    s_nop 11
    v_fma_f32 v96, v96, s10, 0
    v_fma_f32 v97, v97, s10, 0
    v_fma_f32 v98, v98, s10, 0
    v_fma_f32 v99, v99, s10, 0
    v_fma_f32 v100, v100, s10, 0
    v_fma_f32 v101, v101, s10, 0
    v_fma_f32 v102, v102, s10, 0
    v_fma_f32 v103, v103, s10, 0
    v_fma_f32 v104, v104, s10, 0
    v_fma_f32 v105, v105, s10, 0
    v_fma_f32 v106, v106, s10, 0
    v_fma_f32 v107, v107, s10, 0
    v_fma_f32 v108, v108, s10, 0
    v_fma_f32 v109, v109, s10, 0
    v_fma_f32 v110, v110, s10, 0
    v_fma_f32 v111, v111, s10, 0
    v_fma_f32 v112, v112, s10, 0
    v_fma_f32 v113, v113, s10, 0
    v_fma_f32 v114, v114, s10, 0
    v_fma_f32 v115, v115, s10, 0
    v_fma_f32 v116, v116, s10, 0
    v_fma_f32 v117, v117, s10, 0
    v_fma_f32 v118, v118, s10, 0
    v_fma_f32 v119, v119, s10, 0
    v_fma_f32 v120, v120, s10, 0
    v_fma_f32 v121, v121, s10, 0
    v_fma_f32 v122, v122, s10, 0
    v_fma_f32 v123, v123, s10, 0
    v_fma_f32 v124, v124, s10, 0
    v_fma_f32 v125, v125, s10, 0
    v_fma_f32 v126, v126, s10, 0
    v_fma_f32 v127, v127, s10, 0
    v_add_u32 v96, s15, v96
    v_add_u32 v97, s15, v97
    v_add_u32 v98, s15, v98
    v_add_u32 v99, s15, v99
    v_add_u32 v100, s15, v100
    v_add_u32 v101, s15, v101
    v_add_u32 v102, s15, v102
    v_add_u32 v103, s15, v103
    v_add_u32 v104, s15, v104
    v_add_u32 v105, s15, v105
    v_add_u32 v106, s15, v106
    v_add_u32 v107, s15, v107
    v_add_u32 v108, s15, v108
    v_add_u32 v109, s15, v109
    v_add_u32 v110, s15, v110
    v_add_u32 v111, s15, v111
    v_add_u32 v112, s15, v112
    v_add_u32 v113, s15, v113
    v_add_u32 v114, s15, v114
    v_add_u32 v115, s15, v115
    v_add_u32 v116, s15, v116
    v_add_u32 v117, s15, v117
    v_add_u32 v118, s15, v118
    v_add_u32 v119, s15, v119
    v_add_u32 v120, s15, v120
    v_add_u32 v121, s15, v121
    v_add_u32 v122, s15, v122
    v_add_u32 v123, s15, v123
    v_add_u32 v124, s15, v124
    v_add_u32 v125, s15, v125
    v_add_u32 v126, s15, v126
    v_add_u32 v127, s15, v127
    v_sub_u32_sdwa v97, v97, v96 clamp dst_sel:DWORD dst_unused:UNUSED_PAD src0_sel:DWORD src1_sel:WORD_1
    v_sub_u32_sdwa v101, v101, v100 clamp dst_sel:DWORD dst_unused:UNUSED_PAD src0_sel:DWORD src1_sel:WORD_1
    v_sub_u32_sdwa v105, v105, v104 clamp dst_sel:DWORD dst_unused:UNUSED_PAD src0_sel:DWORD src1_sel:WORD_1
    v_sub_u32_sdwa v109, v109, v108 clamp dst_sel:DWORD dst_unused:UNUSED_PAD src0_sel:DWORD src1_sel:WORD_1
    v_sub_u32_sdwa v113, v113, v112 clamp dst_sel:DWORD dst_unused:UNUSED_PAD src0_sel:DWORD src1_sel:WORD_1
    v_sub_u32_sdwa v117, v117, v116 clamp dst_sel:DWORD dst_unused:UNUSED_PAD src0_sel:DWORD src1_sel:WORD_1
    v_sub_u32_sdwa v121, v121, v120 clamp dst_sel:DWORD dst_unused:UNUSED_PAD src0_sel:DWORD src1_sel:WORD_1
    v_sub_u32_sdwa v125, v125, v124 clamp dst_sel:DWORD dst_unused:UNUSED_PAD src0_sel:DWORD src1_sel:WORD_1
    v_sub_u32_sdwa v98, v98, v97 clamp dst_sel:DWORD dst_unused:UNUSED_PAD src0_sel:DWORD src1_sel:WORD_1
    v_sub_u32_sdwa v102, v102, v101 clamp dst_sel:DWORD dst_unused:UNUSED_PAD src0_sel:DWORD src1_sel:WORD_1
    v_sub_u32_sdwa v106, v106, v105 clamp dst_sel:DWORD dst_unused:UNUSED_PAD src0_sel:DWORD src1_sel:WORD_1
    v_sub_u32_sdwa v110, v110, v109 clamp dst_sel:DWORD dst_unused:UNUSED_PAD src0_sel:DWORD src1_sel:WORD_1
    v_sub_u32_sdwa v114, v114, v113 clamp dst_sel:DWORD dst_unused:UNUSED_PAD src0_sel:DWORD src1_sel:WORD_1
    v_sub_u32_sdwa v118, v118, v117 clamp dst_sel:DWORD dst_unused:UNUSED_PAD src0_sel:DWORD src1_sel:WORD_1
    v_sub_u32_sdwa v122, v122, v121 clamp dst_sel:DWORD dst_unused:UNUSED_PAD src0_sel:DWORD src1_sel:WORD_1
    v_sub_u32_sdwa v126, v126, v125 clamp dst_sel:DWORD dst_unused:UNUSED_PAD src0_sel:DWORD src1_sel:WORD_1
    v_sub_u32_sdwa v99, v99, v98 clamp dst_sel:DWORD dst_unused:UNUSED_PAD src0_sel:DWORD src1_sel:WORD_1
    v_sub_u32_sdwa v103, v103, v102 clamp dst_sel:DWORD dst_unused:UNUSED_PAD src0_sel:DWORD src1_sel:WORD_1
    v_sub_u32_sdwa v107, v107, v106 clamp dst_sel:DWORD dst_unused:UNUSED_PAD src0_sel:DWORD src1_sel:WORD_1
    v_sub_u32_sdwa v111, v111, v110 clamp dst_sel:DWORD dst_unused:UNUSED_PAD src0_sel:DWORD src1_sel:WORD_1
    v_sub_u32_sdwa v115, v115, v114 clamp dst_sel:DWORD dst_unused:UNUSED_PAD src0_sel:DWORD src1_sel:WORD_1
    v_sub_u32_sdwa v119, v119, v118 clamp dst_sel:DWORD dst_unused:UNUSED_PAD src0_sel:DWORD src1_sel:WORD_1
    v_sub_u32_sdwa v123, v123, v122 clamp dst_sel:DWORD dst_unused:UNUSED_PAD src0_sel:DWORD src1_sel:WORD_1
    v_sub_u32_sdwa v127, v127, v126 clamp dst_sel:DWORD dst_unused:UNUSED_PAD src0_sel:DWORD src1_sel:WORD_1
    v_perm_b32 v16, v97, v96, s9
    v_perm_b32 v17, v99, v98, s9
    v_perm_b32 v18, v101, v100, s9
    v_perm_b32 v19, v103, v102, s9
    ds_write_b128 v5, v[16:19] offset:0
    v_perm_b32 v20, v105, v104, s9
    v_perm_b32 v21, v107, v106, s9
    v_perm_b32 v22, v109, v108, s9
    v_perm_b32 v23, v111, v110, s9
    ds_write_b128 v5, v[20:23] offset:16
    v_perm_b32 v24, v113, v112, s9
    v_perm_b32 v25, v115, v114, s9
    v_perm_b32 v26, v117, v116, s9
    v_perm_b32 v27, v119, v118, s9
    ds_write_b128 v5, v[24:27] offset:64
    v_perm_b32 v28, v121, v120, s9
    v_perm_b32 v29, v123, v122, s9
    v_perm_b32 v30, v125, v124, s9
    v_perm_b32 v31, v127, v126, s9
    ds_write_b128 v5, v[28:31] offset:80
    s_waitcnt lgkmcnt(0)
    ds_read_b128 v[32:35], v6 offset:0
    ds_read_b128 v[36:39], v6 offset:1152
    ds_read_b128 v[40:43], v6 offset:2304
    ds_read_b128 v[44:47], v6 offset:3456
    s_waitcnt lgkmcnt(3)
    buffer_store_dwordx4 v[32:35], v7, s[44:47], s4 offen sc1
    s_waitcnt lgkmcnt(2)
    buffer_store_dwordx4 v[36:39], v7, s[44:47], s5 offen sc1
    s_waitcnt lgkmcnt(1)
    buffer_store_dwordx4 v[40:43], v7, s[44:47], s6 offen sc1
    s_waitcnt lgkmcnt(0)
    buffer_store_dwordx4 v[44:47], v7, s[44:47], s7 offen sc1
    s_endpgm
K1_PREP:
    v_and_b32 v3, 31, v0
    v_lshrrev_b32 v4, 5, v1
    v_lshlrev_b32 v5, 4, v3
    v_lshl_add_u32 v7, v4, 12, v5
    s_lshl_b32 s5, s2, 13
    s_add_u32 s5, s5, 65536
    s_mov_b32 s6, 512
    s_mov_b32 s7, 1024
    s_mov_b32 s12, 1536
    s_mov_b32 s38, 133120
    s_waitcnt lgkmcnt(0)
    s_mov_b64 s[36:37], s[24:25]
    s_cmp_lt_u32 s2, 8
    s_cbranch_scc1 K1_PRL
    s_mov_b32 s5, 131072
    s_cmp_eq_u32 s2, 16
    s_cbranch_scc1 K1_PRL
    v_lshrrev_b32 v8, 4, v1
    v_and_b32 v6, 15, v1
    v_lshlrev_b32 v7, 4, v6
    v_lshl_add_u32 v7, v8, 12, v7
    s_and_b32 s5, s2, 3
    s_lshl_b32 s5, s5, 14
    s_bfe_u32 s13, s2, 0x10002
    s_lshl_b32 s13, s13, 10
    s_add_u32 s5, s5, s13
    s_mov_b32 s7, 256
    s_mov_b32 s12, 768
    s_mov_b64 s[36:37], s[28:29]
    s_mov_b32 s38, 65536

K1_PRL:
    s_add_u32 s6, s6, s5
    s_add_u32 s7, s7, s5
    s_add_u32 s12, s12, s5

    buffer_load_dwordx4 v[16:19], v7, s[36:39], s5 offen offset:0
    buffer_load_dwordx4 v[20:23], v7, s[36:39], s6 offen offset:0
    buffer_load_dwordx4 v[24:27], v7, s[36:39], s7 offen offset:0
    buffer_load_dwordx4 v[28:31], v7, s[36:39], s12 offen offset:0
    buffer_load_dwordx4 v[32:35], v7, s[36:39], s5 offen offset:2048
    buffer_load_dwordx4 v[36:39], v7, s[36:39], s6 offen offset:2048
    buffer_load_dwordx4 v[40:43], v7, s[36:39], s7 offen offset:2048
    buffer_load_dwordx4 v[44:47], v7, s[36:39], s12 offen offset:2048
    s_barrier
    s_mov_b32 s8, 0x05040100
    s_mov_b32 s9, 0x07060302

    s_add_u32 s44, s32, 0xd00000
    s_addc_u32 s45, s33, 0
    s_mov_b32 s46, 196608
    s_mov_b32 s47, 0x00020000
    v_lshlrev_b32 v11, 4, v1
    v_add_u32 v12, 65536, v11
    s_cmp_eq_u32 s2, 16
    s_cbranch_scc1 K1_PREP3
    s_waitcnt vmcnt(0)

    v_perm_b32 v56, v20, v16, s8
    v_perm_b32 v57, v28, v24, s8
    v_perm_b32 v58, v36, v32, s8
    v_perm_b32 v59, v44, v40, s8
    v_perm_b32 v60, v20, v16, s9
    v_perm_b32 v61, v28, v24, s9
    v_perm_b32 v62, v36, v32, s9
    v_perm_b32 v63, v44, v40, s9
    v_perm_b32 v64, v21, v17, s8
    v_perm_b32 v65, v29, v25, s8
    v_perm_b32 v66, v37, v33, s8
    v_perm_b32 v67, v45, v41, s8
    v_perm_b32 v68, v21, v17, s9
    v_perm_b32 v69, v29, v25, s9
    v_perm_b32 v70, v37, v33, s9
    v_perm_b32 v71, v45, v41, s9
    v_perm_b32 v72, v22, v18, s8
    v_perm_b32 v73, v30, v26, s8
    v_perm_b32 v74, v38, v34, s8
    v_perm_b32 v75, v46, v42, s8
    v_perm_b32 v76, v22, v18, s9
    v_perm_b32 v77, v30, v26, s9
    v_perm_b32 v78, v38, v34, s9
    v_perm_b32 v79, v46, v42, s9
    v_perm_b32 v80, v23, v19, s8
    v_perm_b32 v81, v31, v27, s8
    v_perm_b32 v82, v39, v35, s8
    v_perm_b32 v83, v47, v43, s8
    v_perm_b32 v84, v23, v19, s9
    v_perm_b32 v85, v31, v27, s9
    v_perm_b32 v86, v39, v35, s9
    v_perm_b32 v87, v47, v43, s9
    s_cmp_ge_u32 s2, 8
    s_cbranch_scc1 K1_PREP2
    v_and_b32 v10, 15, v3
    v_lshlrev_b32 v10, 5, v10
    v_lshl_add_u32 v10, v4, 9, v10
    v_lshrrev_b32 v9, 4, v3
    v_lshl_add_u32 v10, v9, 10, v10
    v_add_u32 v10, 65536, v10
    s_lshl_b32 s6, s2, 10
    s_add_u32 s6, s6, 65536
    s_mov_b32 s7, 8192
    s_mov_b32 s12, 8192

    ds_write_b128 v10, v[56:59] offset:0
    ds_write_b128 v10, v[60:63] offset:4096
    ds_write_b128 v10, v[64:67] offset:16
    ds_write_b128 v10, v[68:71] offset:4112
    ds_write_b128 v10, v[72:75] offset:2048
    ds_write_b128 v10, v[76:79] offset:6144
    ds_write_b128 v10, v[80:83] offset:2064
    ds_write_b128 v10, v[84:87] offset:6160
    s_branch K1_PREP_ST
K1_PREP2:
    v_lshrrev_b32 v8, 4, v1
    v_and_b32 v6, 15, v1
    v_lshrrev_b32 v10, 2, v6
    v_lshlrev_b32 v10, 11, v10
    v_lshl_add_u32 v10, v8, 9, v10
    v_and_b32 v9, 1, v6
    v_lshl_add_u32 v10, v9, 8, v10
    v_bfe_u32 v9, v6, 1, 1
    v_lshl_add_u32 v10, v9, 6, v10
    v_add_u32 v10, 65536, v10
    s_sub_u32 s4, s2, 8
    s_lshl_b32 s6, s4, 11
    s_add_u32 s6, s6, 131072
    s_mov_b32 s7, 1024
    s_mov_b32 s12, 15360

    ds_write_b128 v10, v[56:59] offset:0
    ds_write_b128 v10, v[60:63] offset:16
    ds_write_b128 v10, v[64:67] offset:32
    ds_write_b128 v10, v[68:71] offset:48
    ds_write_b128 v10, v[72:75] offset:128
    ds_write_b128 v10, v[76:79] offset:144
    ds_write_b128 v10, v[80:83] offset:160
    ds_write_b128 v10, v[84:87] offset:176
K1_PREP_ST:
    ds_read_b128 v[16:19], v12 offset:0
    ds_read_b128 v[20:23], v12 offset:1024
    ds_read_b128 v[24:27], v12 offset:2048
    ds_read_b128 v[28:31], v12 offset:3072
    ds_read_b128 v[32:35], v12 offset:4096
    ds_read_b128 v[36:39], v12 offset:5120
    ds_read_b128 v[40:43], v12 offset:6144
    ds_read_b128 v[44:47], v12 offset:7168
    s_waitcnt lgkmcnt(7)
    buffer_store_dwordx4 v[16:19], v11, s[44:47], s6 offen sc1
    s_add_u32 s6, s6, s7
    s_waitcnt lgkmcnt(6)
    buffer_store_dwordx4 v[20:23], v11, s[44:47], s6 offen sc1
    s_add_u32 s6, s6, s12
    s_waitcnt lgkmcnt(5)
    buffer_store_dwordx4 v[24:27], v11, s[44:47], s6 offen sc1
    s_add_u32 s6, s6, s7
    s_waitcnt lgkmcnt(4)
    buffer_store_dwordx4 v[28:31], v11, s[44:47], s6 offen sc1
    s_add_u32 s6, s6, s12
    s_waitcnt lgkmcnt(3)
    buffer_store_dwordx4 v[32:35], v11, s[44:47], s6 offen sc1
    s_add_u32 s6, s6, s7
    s_waitcnt lgkmcnt(2)
    buffer_store_dwordx4 v[36:39], v11, s[44:47], s6 offen sc1
    s_add_u32 s6, s6, s12
    s_waitcnt lgkmcnt(1)
    buffer_store_dwordx4 v[40:43], v11, s[44:47], s6 offen sc1
    s_add_u32 s6, s6, s7
    s_waitcnt lgkmcnt(0)
    buffer_store_dwordx4 v[44:47], v11, s[44:47], s6 offen sc1
    s_add_u32 s6, s6, s12
    s_barrier
    s_endpgm
K1_PREP3:
    s_mov_b32 exec_hi, 0
    s_mov_b32 s10, 0xbfb8aa3b
    s_waitcnt vmcnt(0)

    v_lshlrev_b32 v56, 16, v16
    v_and_b32 v57, 0xffff0000, v16
    v_lshlrev_b32 v58, 16, v17
    v_and_b32 v59, 0xffff0000, v17
    v_lshlrev_b32 v60, 16, v18
    v_and_b32 v61, 0xffff0000, v18
    v_lshlrev_b32 v62, 16, v19
    v_and_b32 v63, 0xffff0000, v19
    v_lshlrev_b32 v64, 16, v20
    v_and_b32 v65, 0xffff0000, v20
    v_lshlrev_b32 v66, 16, v21
    v_and_b32 v67, 0xffff0000, v21
    v_lshlrev_b32 v68, 16, v22
    v_and_b32 v69, 0xffff0000, v22
    v_lshlrev_b32 v70, 16, v23
    v_and_b32 v71, 0xffff0000, v23
    v_lshlrev_b32 v72, 16, v24
    v_and_b32 v73, 0xffff0000, v24
    v_lshlrev_b32 v74, 16, v25
    v_and_b32 v75, 0xffff0000, v25
    v_lshlrev_b32 v76, 16, v26
    v_and_b32 v77, 0xffff0000, v26
    v_lshlrev_b32 v78, 16, v27
    v_and_b32 v79, 0xffff0000, v27
    v_lshlrev_b32 v80, 16, v28
    v_and_b32 v81, 0xffff0000, v28
    v_lshlrev_b32 v82, 16, v29
    v_and_b32 v83, 0xffff0000, v29
    v_lshlrev_b32 v84, 16, v30
    v_and_b32 v85, 0xffff0000, v30
    v_lshlrev_b32 v86, 16, v31
    v_and_b32 v87, 0xffff0000, v31
    v_mul_f32 v56, s10, v56
    v_mul_f32 v57, s10, v57
    v_mul_f32 v58, s10, v58
    v_mul_f32 v59, s10, v59
    v_mul_f32 v60, s10, v60
    v_mul_f32 v61, s10, v61
    v_mul_f32 v62, s10, v62
    v_mul_f32 v63, s10, v63
    v_mul_f32 v64, s10, v64
    v_mul_f32 v65, s10, v65
    v_mul_f32 v66, s10, v66
    v_mul_f32 v67, s10, v67
    v_mul_f32 v68, s10, v68
    v_mul_f32 v69, s10, v69
    v_mul_f32 v70, s10, v70
    v_mul_f32 v71, s10, v71
    v_mul_f32 v72, s10, v72
    v_mul_f32 v73, s10, v73
    v_mul_f32 v74, s10, v74
    v_mul_f32 v75, s10, v75
    v_mul_f32 v76, s10, v76
    v_mul_f32 v77, s10, v77
    v_mul_f32 v78, s10, v78
    v_mul_f32 v79, s10, v79
    v_mul_f32 v80, s10, v80
    v_mul_f32 v81, s10, v81
    v_mul_f32 v82, s10, v82
    v_mul_f32 v83, s10, v83
    v_mul_f32 v84, s10, v84
    v_mul_f32 v85, s10, v85
    v_mul_f32 v86, s10, v86
    v_mul_f32 v87, s10, v87
    v_cvt_pk_bf16_f32 v16, v56, v64
    v_cvt_pk_bf16_f32 v17, v58, v66
    v_cvt_pk_bf16_f32 v18, v72, v80
    v_cvt_pk_bf16_f32 v19, v74, v82
    buffer_store_dwordx4 v[16:19], v5, s[44:47], 0 offen offset:0 sc1
    v_cvt_pk_bf16_f32 v20, v60, v68
    v_cvt_pk_bf16_f32 v21, v62, v70
    v_cvt_pk_bf16_f32 v22, v76, v84
    v_cvt_pk_bf16_f32 v23, v78, v86
    buffer_store_dwordx4 v[20:23], v5, s[44:47], 0 offen offset:512 sc1
    v_cvt_pk_bf16_f32 v24, v57, v65
    v_cvt_pk_bf16_f32 v25, v59, v67
    v_cvt_pk_bf16_f32 v26, v73, v81
    v_cvt_pk_bf16_f32 v27, v75, v83
    buffer_store_dwordx4 v[24:27], v5, s[44:47], 0 offen offset:1024 sc1
    v_cvt_pk_bf16_f32 v28, v61, v69
    v_cvt_pk_bf16_f32 v29, v63, v71
    v_cvt_pk_bf16_f32 v30, v77, v85
    v_cvt_pk_bf16_f32 v31, v79, v87
    buffer_store_dwordx4 v[28:31], v5, s[44:47], 0 offen offset:1536 sc1
    s_barrier
    s_endpgm
.p2align 8
k2_kernel:
    s_cmp_ge_u32 s2, 256
    s_cbranch_scc1 K2_END0

    s_load_dwordx4 s[24:27], s[0:1], 72
    s_load_dwordx2 s[16:17], s[0:1], 0
    s_load_dwordx2 s[18:19], s[0:1], 40
    s_load_dwordx4 s[20:23], s[0:1], 56
    s_mov_b32 s65, 0
    v_lshrrev_b32 v122, 6, v0
    s_and_b32 s13, s2, 7
    v_readfirstlane_b32 s3, v122
    s_lshl_b32 s13, s13, 5
    s_lshr_b32 s4, s2, 3
    s_add_u32 s13, s13, s4
    s_mul_i32 s66, s13, 49
    s_mov_b32 s73, 0
    s_mov_b32 s34, 0
    v_mov_b32 v8, 0
    v_mov_b32 v9, 0

K2_ROUND:
    s_mov_b32 s59, 0x00020000
    s_cmp_ge_u32 s3, 8
    s_cbranch_scc1 K2_QW0
    v_lshrrev_b32 v122, 2, v0

    v_lshlrev_b32 v123, 10, v122
    s_lshl_b32 s4, s13, 2
    s_mov_b32 s58, 128000

    s_waitcnt lgkmcnt(0)
    s_add_u32 s56, s26, 0xc00000
    s_addc_u32 s57, s27, 0
    buffer_load_dword v7, v123, s[56:59], s4 offen
    s_branch K2_COMMON

K2_END0:
    s_endpgm
K2_QW0:
    v_and_b32 v122, 511, v0
    v_lshlrev_b32 v124, 4, v122
    s_lshl_b32 s5, s66, 8
    s_add_u32 s6, s5, 8192
    s_mov_b32 s58, 3200000
    s_waitcnt lgkmcnt(0)
    s_mov_b64 s[56:57], s[16:17]

K2_COMMON:
    s_add_u32 s40, s26, 0x700000
    s_addc_u32 s41, s27, 0
    s_mov_b32 s42, 4800000
    s_mov_b32 s43, 0x00020000
    s_add_u32 s44, s26, 0xd00000
    s_addc_u32 s45, s27, 0
    s_mov_b32 s46, 196608
    s_mov_b32 s47, 0x00020000
    s_mov_b32 s36, s26
    s_mov_b32 s37, s27
    s_and_b32 s37, s37, 0xffff
    s_or_b32 s37, s37, 0x2000000
    s_mov_b32 s38, 12500
    s_mov_b32 s39, 0x00020000
    s_mov_b32 s52, s22
    s_mov_b32 s53, s23
    s_mov_b32 s54, 3200000
    s_mov_b32 s55, 0x00020000
    v_and_b32 v100, 63, v0
    v_lshlrev_b32 v4, 4, v100
    v_and_b32 v101, 31, v0
    v_bfe_u32 v104, v0, 5, 1
    s_sub_u32 s67, 12500, s66
    s_min_u32 s67, s67, 49
    s_mov_b32 s30, 0x33333333
    s_mov_b32 s31, 0xcccccccc
    s_mov_b32 s74, 0x3f80
    s_mov_b32 s75, 0
    s_mov_b32 s69, 10
    s_and_b32 s14, s3, 3
    s_lshl_b32 s14, s14, 2
    s_lshr_b32 s4, s3, 2
    s_add_u32 s14, s14, s4
    v_mov_b32 v112, 1
    v_cmp_gt_u32 vcc, s67, v100
    s_mov_b64 s[8:9], vcc
    s_cmp_ge_u32 s3, 8
    s_cbranch_scc1 K2_QWAVE

    s_setprio 0
    v_mov_b32 v10, 0
    v_mov_b32 v11, 0
    v_lshlrev_b32 v125, 3, v0
    ds_write_b64 v125, v[10:11]
    v_and_b32 v125, 3, v0
    v_mul_u32_u24 v126, 3200, v122
    s_mul_i32 s4, s34, 48
    s_waitcnt vmcnt(0)
    v_and_b32 v123, 0xffff, v7
    v_lshrrev_b32 v124, 16, v7
    v_add3_u32 v123, v123, v126, v125
    v_mul_u32_u24 v105, 12, v123
    v_sub_u32 v108, v124, v125
    v_add_u32 v108, 3, v108
    v_lshrrev_b32 v108, 2, v108
    v_subrev_u32 v108, s34, v108
    v_max_i32 v108, 0, v108

    v_cmpx_lt_u32 vcc, 0, v108
    buffer_load_dwordx3 v[26:28], v105, s[40:43], s4 offen offset:0
    v_cmpx_lt_u32 vcc, 1, v108
    buffer_load_dwordx3 v[30:32], v105, s[40:43], s4 offen offset:48
    v_cmpx_lt_u32 vcc, 2, v108
    buffer_load_dwordx3 v[34:36], v105, s[40:43], s4 offen offset:96
    v_cmpx_lt_u32 vcc, 3, v108
    buffer_load_dwordx3 v[38:40], v105, s[40:43], s4 offen offset:144
    v_cmpx_lt_u32 vcc, 4, v108
    s_cbranch_execz K2_ELD_DONE
    buffer_load_dwordx3 v[42:44], v105, s[40:43], s4 offen offset:192
    v_cmpx_lt_u32 vcc, 5, v108
    s_cbranch_execz K2_ELD_DONE
    buffer_load_dwordx3 v[46:48], v105, s[40:43], s4 offen offset:240
    v_cmpx_lt_u32 vcc, 6, v108
    s_cbranch_execz K2_ELD_DONE
    buffer_load_dwordx3 v[50:52], v105, s[40:43], s4 offen offset:288
    v_cmpx_lt_u32 vcc, 7, v108
    s_cbranch_execz K2_ELD_DONE
    buffer_load_dwordx3 v[54:56], v105, s[40:43], s4 offen offset:336
    v_cmpx_lt_u32 vcc, 8, v108
    s_cbranch_execz K2_ELD_DONE
    buffer_load_dwordx3 v[58:60], v105, s[40:43], s4 offen offset:384
    v_cmpx_lt_u32 vcc, 9, v108
    s_cbranch_execz K2_ELD_DONE
    buffer_load_dwordx3 v[62:64], v105, s[40:43], s4 offen offset:432
K2_ELD_DONE:
    s_mov_b64 exec, -1
    s_waitcnt lgkmcnt(0)
    s_barrier

K2_HIST:
    v_min_u32 v109, s69, v108
    s_waitcnt vmcnt(0)

    v_cmpx_lt_u32 vcc, 0, v109
    v_lshrrev_b32 v66, 14, v28
    ds_add_rtn_u32 v29, v66, v112 offset:0
    v_cmpx_lt_u32 vcc, 1, v109
    v_lshrrev_b32 v67, 14, v32
    ds_add_rtn_u32 v33, v67, v112 offset:0
    v_cmpx_lt_u32 vcc, 2, v109
    v_lshrrev_b32 v68, 14, v36
    ds_add_rtn_u32 v37, v68, v112 offset:0
    v_cmpx_lt_u32 vcc, 3, v109
    v_lshrrev_b32 v69, 14, v40
    ds_add_rtn_u32 v41, v69, v112 offset:0
    v_cmpx_lt_u32 vcc, 4, v109
    s_cbranch_execz K2_HIST_DONE
    v_lshrrev_b32 v70, 14, v44
    ds_add_rtn_u32 v45, v70, v112 offset:0
    v_cmpx_lt_u32 vcc, 5, v109
    s_cbranch_execz K2_HIST_DONE
    v_lshrrev_b32 v71, 14, v48
    ds_add_rtn_u32 v49, v71, v112 offset:0
    v_cmpx_lt_u32 vcc, 6, v109
    s_cbranch_execz K2_HIST_DONE
    v_lshrrev_b32 v72, 14, v52
    ds_add_rtn_u32 v53, v72, v112 offset:0
    v_cmpx_lt_u32 vcc, 7, v109
    s_cbranch_execz K2_HIST_DONE
    v_lshrrev_b32 v73, 14, v56
    ds_add_rtn_u32 v57, v73, v112 offset:0
    v_cmpx_lt_u32 vcc, 8, v109
    s_cbranch_execz K2_HIST_DONE
    v_lshrrev_b32 v74, 14, v60
    ds_add_rtn_u32 v61, v74, v112 offset:0
    v_cmpx_lt_u32 vcc, 9, v109
    s_cbranch_execz K2_HIST_DONE
    v_lshrrev_b32 v75, 14, v64
    ds_add_rtn_u32 v65, v75, v112 offset:0
K2_HIST_DONE:
    s_mov_b64 exec, -1
    v_mov_b32 v122, 0
    v_cmp_lt_u32 vcc, s69, v108
    s_mov_b64 exec, vcc
    ds_add_u32 v122, v112 offset:252
    s_mov_b64 exec, 1
    s_waitcnt lgkmcnt(0)
    ds_add_u32 v122, v112 offset:248
    s_mov_b64 exec, -1

    s_branch K2_SCAN
K2_QWAVE:
    v_lshlrev_b32 v126, 2, v122

    v_mov_b32 v42, 0x3fff
    v_mov_b32 v43, 0x3fff
    v_mov_b32 v44, 0x3fff
    v_mov_b32 v45, 0x3fff
    ds_write_b128 v124, v[42:45] offset:6656
    ds_write_b128 v124, v[42:45] offset:14848
    v_mov_b32 v46, 0
    v_lshlrev_b32 v125, 1, v122
    v_add_u32 v125, 139840, v125
    ds_write_b16 v125, v46
    s_lshr_b32 s12, s2, 3
    s_add_u32 s12, s12, s3
    s_and_b32 s12, s12, 7
    s_lshl_b32 s5, s12, 13
    s_add_u32 s5, s5, 65536
    s_add_u32 s6, s5, 4096
    s_mov_b64 s[56:57], s[18:19]
    s_mov_b32 s58, 512
    s_lshr_b32 s4, s12, 2
    s_lshl_b32 s4, s4, 1
    s_and_b32 s7, s12, 2
    s_lshl_b32 s7, s7, 2
    s_add_u32 s4, s4, s7
    s_and_b32 s7, s12, 1
    s_lshl_b32 s7, s7, 8
    s_add_u32 s4, s4, s7
    v_lshrrev_b32 v123, 1, v101
    v_lshlrev_b32 v123, 4, v123
    v_and_b32 v125, 1, v101
    v_lshl_add_u32 v123, v125, 2, v123
    v_mov_b32 v113, v123
    v_lshrrev_b32 v127, 4, v122
    v_lshl_add_u32 v127, v127, 4, v124
    v_add_u32 v127, 85760, v127
    v_mul_u32_u24 v122, 272, v101
    v_lshl_add_u32 v122, v104, 4, v122
    v_add_u32 v122, 85760, v122
    s_setprio 0
    s_cmp_lg_u32 s73, 0
    s_cbranch_scc1 K2_QSKIP
    s_cmp_lt_u32 s3, 16
    s_cbranch_scc1 K2_W1LATE

K2_W1LATE:
    s_mov_b32 s48, s16
    s_mov_b32 s49, s17
    s_mov_b32 s50, 3200000
    s_mov_b32 s51, 0x00020000
    s_lshl_b32 s10, s66, 8
    s_add_u32 s11, s10, 8192
    v_lshlrev_b32 v124, 2, v126
    s_waitcnt lgkmcnt(0)
    s_barrier
    buffer_load_dwordx4 v[74:77], v124, s[48:51], s10 offen
    buffer_load_dwordx4 v[78:81], v124, s[48:51], s11 offen
    buffer_load_dword v7, v126, s[44:47], 0 offen

    buffer_load_ushort v6, v123, s[56:59], s4 offen
    buffer_load_dwordx4 v[10:13], v4, s[44:47], s5 offen offset:0
    buffer_load_dwordx4 v[14:17], v4, s[44:47], s5 offen offset:1024
    buffer_load_dwordx4 v[18:21], v4, s[44:47], s5 offen offset:2048
    buffer_load_dwordx4 v[22:25], v4, s[44:47], s5 offen offset:3072
    buffer_load_dwordx4 v[26:29], v4, s[44:47], s6 offen offset:0
    buffer_load_dwordx4 v[30:33], v4, s[44:47], s6 offen offset:1024
    buffer_load_dwordx4 v[34:37], v4, s[44:47], s6 offen offset:2048
    buffer_load_dwordx4 v[38:41], v4, s[44:47], s6 offen offset:3072
    v_mov_b32 v124, 0
    s_waitcnt vmcnt(9)
    ds_write_b32 v126, v7 offset:4608
    ds_write_b128 v127, v[74:77]
    ds_write_b128 v127, v[78:81] offset:8704
    s_waitcnt lgkmcnt(0)
    s_mov_b64 exec, 1
    ds_add_u32 v124, v112 offset:2304
    s_mov_b64 exec, -1

    s_branch K2_XS1
K2_XS:
    s_sleep 1
K2_XS1:
    ds_read_b32 v125, v124 offset:2304
    s_waitcnt lgkmcnt(0)
    v_readfirstlane_b32 s4, v125
    s_cmp_lt_u32 s4, 8
    s_cbranch_scc1 K2_XS

K2_W1DONE:
    ds_read_b128 v[74:77], v122 offset:0
    ds_read_b128 v[78:81], v122 offset:8704
    ds_read_b128 v[82:85], v122 offset:32
    ds_read_b128 v[86:89], v122 offset:8736
    ds_read_b128 v[90:93], v122 offset:64
    ds_read_b128 v[94:97], v122 offset:8768
    ds_read_b128 v[114:117], v122 offset:96
    ds_read_b128 v[118:121], v122 offset:8800
    s_waitcnt vmcnt(7) lgkmcnt(6)
    v_mfma_f32_32x32x16_bf16 v[42:57], v[74:77], v[10:13], 0
    v_mfma_f32_32x32x16_bf16 v[58:73], v[78:81], v[10:13], 0
    ds_read_b128 v[74:77], v122 offset:128
    ds_read_b128 v[78:81], v122 offset:8832
    s_waitcnt vmcnt(6) lgkmcnt(6)
    v_mfma_f32_32x32x16_bf16 v[42:57], v[82:85], v[14:17], v[42:57]
    v_mfma_f32_32x32x16_bf16 v[58:73], v[86:89], v[14:17], v[58:73]
    ds_read_b128 v[82:85], v122 offset:160
    ds_read_b128 v[86:89], v122 offset:8864
    s_waitcnt vmcnt(5) lgkmcnt(6)
    v_mfma_f32_32x32x16_bf16 v[42:57], v[90:93], v[18:21], v[42:57]
    v_mfma_f32_32x32x16_bf16 v[58:73], v[94:97], v[18:21], v[58:73]
    ds_read_b128 v[90:93], v122 offset:192
    ds_read_b128 v[94:97], v122 offset:8896
    s_waitcnt vmcnt(4) lgkmcnt(6)
    v_mfma_f32_32x32x16_bf16 v[42:57], v[114:117], v[22:25], v[42:57]
    v_mfma_f32_32x32x16_bf16 v[58:73], v[118:121], v[22:25], v[58:73]
    ds_read_b128 v[114:117], v122 offset:224
    ds_read_b128 v[118:121], v122 offset:8928
    s_waitcnt vmcnt(3) lgkmcnt(6)
    v_mfma_f32_32x32x16_bf16 v[42:57], v[74:77], v[26:29], v[42:57]
    v_mfma_f32_32x32x16_bf16 v[58:73], v[78:81], v[26:29], v[58:73]
    s_waitcnt vmcnt(2) lgkmcnt(4)
    v_mfma_f32_32x32x16_bf16 v[42:57], v[82:85], v[30:33], v[42:57]
    v_mfma_f32_32x32x16_bf16 v[58:73], v[86:89], v[30:33], v[58:73]
    s_waitcnt vmcnt(1) lgkmcnt(2)
    v_mfma_f32_32x32x16_bf16 v[42:57], v[90:93], v[34:37], v[42:57]
    v_mfma_f32_32x32x16_bf16 v[58:73], v[94:97], v[34:37], v[58:73]
    s_waitcnt vmcnt(0) lgkmcnt(0)
    v_mfma_f32_32x32x16_bf16 v[42:57], v[114:117], v[38:41], v[42:57]
    v_mfma_f32_32x32x16_bf16 v[58:73], v[118:121], v[38:41], v[58:73]
    s_mov_b32 s10, 0xbfb8aa3b
    v_lshlrev_b32 v122, 16, v6
    v_mul_f32 v122, s10, v122
    v_mov_b32 v123, s10
    s_lshl_b32 s4, s12, 8
    s_add_u32 s4, s4, 59136
    v_lshl_add_u32 v125, v104, 11, v113
    v_add_u32 v125, s4, v125
    s_nop 7

    v_fma_f32 v42, v42, v123, v122
    v_fma_f32 v43, v43, v123, v122
    v_fma_f32 v44, v44, v123, v122
    v_fma_f32 v45, v45, v123, v122
    v_cvt_pk_bf16_f32 v42, v42, v43
    v_cvt_pk_bf16_f32 v43, v44, v45
    ds_write2_b32 v125, v42, v43 offset0:0 offset1:2
    v_add_u32 v125, 4096, v125
    v_fma_f32 v46, v46, v123, v122
    v_fma_f32 v47, v47, v123, v122
    v_fma_f32 v48, v48, v123, v122
    v_fma_f32 v49, v49, v123, v122
    v_cvt_pk_bf16_f32 v46, v46, v47
    v_cvt_pk_bf16_f32 v47, v48, v49
    ds_write2_b32 v125, v46, v47 offset0:0 offset1:2
    v_add_u32 v125, 4096, v125
    v_fma_f32 v50, v50, v123, v122
    v_fma_f32 v51, v51, v123, v122
    v_fma_f32 v52, v52, v123, v122
    v_fma_f32 v53, v53, v123, v122
    v_cvt_pk_bf16_f32 v50, v50, v51
    v_cvt_pk_bf16_f32 v51, v52, v53
    ds_write2_b32 v125, v50, v51 offset0:0 offset1:2
    v_add_u32 v125, 4096, v125
    v_fma_f32 v54, v54, v123, v122
    v_fma_f32 v55, v55, v123, v122
    v_fma_f32 v56, v56, v123, v122
    v_fma_f32 v57, v57, v123, v122
    v_cvt_pk_bf16_f32 v54, v54, v55
    v_cvt_pk_bf16_f32 v55, v56, v57
    ds_write2_b32 v125, v54, v55 offset0:0 offset1:2
    v_add_u32 v125, 4096, v125
    v_fma_f32 v58, v58, v123, v122
    v_fma_f32 v59, v59, v123, v122
    v_fma_f32 v60, v60, v123, v122
    v_fma_f32 v61, v61, v123, v122
    v_cvt_pk_bf16_f32 v58, v58, v59
    v_cvt_pk_bf16_f32 v59, v60, v61
    ds_write2_b32 v125, v58, v59 offset0:0 offset1:2
    v_add_u32 v125, 4096, v125
    v_fma_f32 v62, v62, v123, v122
    v_fma_f32 v63, v63, v123, v122
    v_fma_f32 v64, v64, v123, v122
    v_fma_f32 v65, v65, v123, v122
    v_cvt_pk_bf16_f32 v62, v62, v63
    v_cvt_pk_bf16_f32 v63, v64, v65
    ds_write2_b32 v125, v62, v63 offset0:0 offset1:2
    v_add_u32 v125, 4096, v125
    v_fma_f32 v66, v66, v123, v122
    v_fma_f32 v67, v67, v123, v122
    v_fma_f32 v68, v68, v123, v122
    v_fma_f32 v69, v69, v123, v122
    v_cvt_pk_bf16_f32 v66, v66, v67
    v_cvt_pk_bf16_f32 v67, v68, v69
    s_mov_b32 exec_hi, 0
    ds_write2_b32 v125, v66, v67 offset0:0 offset1:2
    s_mov_b64 exec, -1
K2_SCAN:
    v_lshlrev_b32 v122, 2, v100
    v_mov_b32 v91, 0

    s_branch K2_HSPIN1
K2_HSPIN:
    s_sleep 1
K2_HSPIN1:
    ds_read_b32 v90, v122 offset:0
    s_waitcnt lgkmcnt(0)
    v_readlane_b32 s4, v90, 62
    s_cmp_lt_u32 s4, 8
    s_cbranch_scc1 K2_HSPIN

    v_readlane_b32 s68, v90, 63
    s_mov_b64 exec, s[8:9]
    v_add_u32 v91, 1, v90
    v_lshrrev_b32 v91, 1, v91
    v_max_u32 v91, 1, v91
    s_mov_b64 exec, -1
    v_mov_b32 v92, v91

    s_nop 1
    v_add_u32_dpp v92, v92, v92 row_shr:1 row_mask:0xf bank_mask:0xf bound_ctrl:0
    s_nop 1
    v_add_u32_dpp v92, v92, v92 row_shr:2 row_mask:0xf bank_mask:0xf bound_ctrl:0
    s_nop 1
    v_add_u32_dpp v92, v92, v92 row_shr:4 row_mask:0xf bank_mask:0xf bound_ctrl:0
    s_nop 1
    v_add_u32_dpp v92, v92, v92 row_shr:8 row_mask:0xf bank_mask:0xf bound_ctrl:0
    s_nop 1
    v_add_u32_dpp v92, v92, v92 row_bcast:15 row_mask:0xa bank_mask:0xf
    s_nop 1
    v_add_u32_dpp v92, v92, v92 row_bcast:31 row_mask:0xc bank_mask:0xf
    v_sub_u32 v96, v92, v91
    s_nop 0
    v_readlane_b32 s4, v92, 63
    v_mov_b32_dpp v93, v92 quad_perm:[3,3,3,3] row_mask:0xf bank_mask:0xf
    v_mov_b32_dpp v123, v96 quad_perm:[0,0,0,0] row_mask:0xf bank_mask:0xf
    s_cmp_gt_u32 s4, 1049
    s_cbranch_scc1 K2_TOOMANY
    v_sub_u32 v93, v93, v123
    v_sub_u32 v96, v96, v123
    v_add_u32 v94, 3, v93
    v_lshrrev_b32 v94, 2, v94
    v_mov_b32 v95, v94
    s_nop 1
    v_add_u32_dpp v95, v95, v95 row_shr:4 row_mask:0xf bank_mask:0xf bound_ctrl:0
    s_nop 1
    v_add_u32_dpp v95, v95, v95 row_shr:8 row_mask:0xf bank_mask:0xf bound_ctrl:0
    s_nop 1
    v_add_u32_dpp v95, v95, v95 row_bcast:15 row_mask:0xa bank_mask:0xf
    s_nop 1
    v_add_u32_dpp v95, v95, v95 row_bcast:31 row_mask:0xc bank_mask:0xf
    s_nop 0
    v_readlane_b32 s72, v95, 63
    v_sub_u32 v95, v95, v94
    v_lshl_add_u32 v96, v95, 2, v96
    v_lshlrev_b32 v97, 1, v96
    s_cmp_ge_u32 s3, 8
    s_cbranch_scc1 K2_META

    ds_bpermute_b32 v76, v66, v97
    ds_bpermute_b32 v77, v67, v97
    ds_bpermute_b32 v78, v68, v97
    ds_bpermute_b32 v79, v69, v97
    ds_bpermute_b32 v80, v70, v97
    v_cmp_lt_u32 vcc, 5, v109
    s_cbranch_vccz K2_BP_DONE
    ds_bpermute_b32 v81, v71, v97
    v_cmp_lt_u32 vcc, 6, v109
    s_cbranch_vccz K2_BP_DONE
    ds_bpermute_b32 v82, v72, v97
    v_cmp_lt_u32 vcc, 7, v109
    s_cbranch_vccz K2_BP_DONE
    ds_bpermute_b32 v83, v73, v97
    v_cmp_lt_u32 vcc, 8, v109
    s_cbranch_vccz K2_BP_DONE
    ds_bpermute_b32 v84, v74, v97
    v_cmp_lt_u32 vcc, 9, v109
    s_cbranch_vccz K2_BP_DONE
    ds_bpermute_b32 v85, v75, v97
K2_BP_DONE:
    s_waitcnt lgkmcnt(0)
    v_cmpx_lt_u32 vcc, 0, v109
    v_add_lshl_u32 v76, v76, v29, 2
    ds_write_b16 v76, v28 offset:6656
    v_cmpx_lt_u32 vcc, 1, v109
    v_add_lshl_u32 v77, v77, v33, 2
    ds_write_b16 v77, v32 offset:6656
    v_cmpx_lt_u32 vcc, 2, v109
    v_add_lshl_u32 v78, v78, v37, 2
    ds_write_b16 v78, v36 offset:6656
    v_cmpx_lt_u32 vcc, 3, v109
    v_add_lshl_u32 v79, v79, v41, 2
    ds_write_b16 v79, v40 offset:6656
    v_cmpx_lt_u32 vcc, 4, v109
    s_cbranch_execz K2_IDX_DONE
    v_add_lshl_u32 v80, v80, v45, 2
    ds_write_b16 v80, v44 offset:6656
    v_cmpx_lt_u32 vcc, 5, v109
    s_cbranch_execz K2_IDX_DONE
    v_add_lshl_u32 v81, v81, v49, 2
    ds_write_b16 v81, v48 offset:6656
    v_cmpx_lt_u32 vcc, 6, v109
    s_cbranch_execz K2_IDX_DONE
    v_add_lshl_u32 v82, v82, v53, 2
    ds_write_b16 v82, v52 offset:6656
    v_cmpx_lt_u32 vcc, 7, v109
    s_cbranch_execz K2_IDX_DONE
    v_add_lshl_u32 v83, v83, v57, 2
    ds_write_b16 v83, v56 offset:6656
    v_cmpx_lt_u32 vcc, 8, v109
    s_cbranch_execz K2_IDX_DONE
    v_add_lshl_u32 v84, v84, v61, 2
    ds_write_b16 v84, v60 offset:6656
    v_cmpx_lt_u32 vcc, 9, v109
    s_cbranch_execz K2_IDX_DONE
    v_add_lshl_u32 v85, v85, v65, 2
    ds_write_b16 v85, v64 offset:6656
K2_IDX_DONE:
    s_mov_b64 exec, 1
    s_waitcnt lgkmcnt(0)
    ds_add_u32 v122, v112 offset:244
    s_branch K2_RANGE

K2_QSKIP:
    s_waitcnt vmcnt(0) lgkmcnt(0)
    s_barrier

    s_branch K2_SCAN
K2_META:
    s_cmp_lg_u32 s3, 8
    s_cbranch_scc1 K2_RANGE
    v_mov_b32 v46, 0
    v_mov_b32 v47, 0
    v_mov_b32 v48, 0
    v_mov_b32 v49, 0
    s_cmp_lg_u32 s73, 0
    s_cbranch_scc1 K2_DEGADD
    ds_write_b32 v122, v46 offset:4096
    ds_write_b32 v122, v46 offset:4352

K2_DEGADD:
    ds_add_u32 v122, v90 offset:4096
    s_mov_b64 exec, s[8:9]
    v_and_b32 v42, 0xfffc, v96
    v_and_b32 v43, 3, v96
    v_lshlrev_b32 v43, v43, v112
    v_mul_u32_u24 v43, 0x11, v43
    ds_or_b32 v42, v43 offset:256
    v_lshlrev_b32 v44, 1, v91
    v_cmp_ne_u32 vcc, v44, v90
    v_add_u32 v44, v44, v97
    v_lshlrev_b32 v44, 4, v44
    s_and_b64 exec, exec, vcc
    ds_write_b128 v44, v[46:49] offset:23024
    v_cmp_eq_u32 vcc, 0, v90
    s_and_b64 exec, exec, vcc
    ds_write_b128 v44, v[46:49] offset:23008
    s_mov_b32 s4, 0x11111111
    s_mov_b32 s5, 0x11111111
    s_and_b64 exec, s[8:9], s[4:5]
    v_mov_b32 v43, 0x1000
    ds_or_b32 v42, v43 offset:256
    v_and_b32 v43, 3, v93
    v_cmp_ne_u32 vcc, 0, v43
    s_and_b64 exec, exec, vcc
    v_add_lshl_u32 v42, v95, v94, 2
    v_lshlrev_b32 v43, v43, v112
    v_mul_u32_u24 v43, 0x101, v43
    ds_or_b32 v42, v43 offset:252
    s_mov_b64 exec, -1
    v_mov_b32 v42, v96
    v_mov_b32 v43, v91

K2_CUTLOOP:
    v_cmp_lt_u32 vcc, 24, v43
    s_mov_b64 exec, vcc
    s_cbranch_execz K2_RANGE
    v_add_u32 v42, 24, v42
    v_subrev_u32 v43, 24, v43
    v_and_b32 v44, 0xfffc, v42
    v_and_b32 v45, 3, v42
    v_lshlrev_b32 v45, v45, v112
    ds_or_b32 v44, v45 offset:256
    s_branch K2_CUTLOOP

K2_RANGE:
    s_mov_b64 exec, -1
    s_add_u32 s34, s34, s69
    s_mul_i32 s4, s72, s14
    s_lshr_b32 s5, s4, 4
    s_add_u32 s4, s4, s72
    s_lshr_b32 s4, s4, 4
    s_sub_u32 s63, s4, s5
    s_lshl_b32 s7, s5, 5
    s_add_u32 s7, s7, 6656
    v_lshlrev_b32 v2, 2, v104
    v_add_u32 v2, s7, v2
    s_cmp_lg_u32 s63, 0
    s_cselect_b32 s38, 12500, 0
    v_lshlrev_b32 v115, 4, v101
    v_lshlrev_b32 v117, 4, v101
    v_lshlrev_b32 v119, 4, v101
    v_lshlrev_b32 v121, 4, v101
    v_mov_b32 v125, 244

    s_branch K2_ISPIN1
K2_ISPIN:
    s_sleep 1
K2_ISPIN1:
    ds_read_b32 v123, v125
    ds_read_b32 v114, v2 offset:0
    ds_read_b32 v116, v2 offset:8
    ds_read_b32 v118, v2 offset:16
    ds_read_b32 v120, v2 offset:24
    s_waitcnt lgkmcnt(0)
    v_readfirstlane_b32 s4, v123
    s_cmp_lt_u32 s4, 8
    s_cbranch_scc1 K2_ISPIN

    buffer_load_dwordx4 v[10:13], v[114:115], s[36:39], 0 idxen offen
    buffer_load_dwordx4 v[14:17], v[116:117], s[36:39], 0 idxen offen
    buffer_load_dwordx4 v[18:21], v[118:119], s[36:39], 0 idxen offen
    buffer_load_dwordx4 v[22:25], v[120:121], s[36:39], 0 idxen offen
    ds_read_b32 v114, v2 offset:32
    ds_read_b32 v116, v2 offset:40
    ds_read_b32 v118, v2 offset:48
    ds_read_b32 v120, v2 offset:56
    s_cmp_ge_u32 s3, 8
    s_cbranch_scc1 K2_SCAT_DONE

    v_cmpx_lt_u32 vcc, 0, v109
    v_lshlrev_b32 v123, 2, v66
    v_lshlrev_b32 v126, 2, v76
    v_lshlrev_b64 v[28:29], v123, s[74:75]
    ds_write_b128 v126, v[26:29] offset:23040
    v_cmpx_lt_u32 vcc, 1, v109
    v_lshlrev_b32 v123, 2, v67
    v_lshlrev_b32 v126, 2, v77
    v_lshlrev_b64 v[32:33], v123, s[74:75]
    ds_write_b128 v126, v[30:33] offset:23040
    v_cmpx_lt_u32 vcc, 2, v109
    v_lshlrev_b32 v123, 2, v68
    v_lshlrev_b32 v126, 2, v78
    v_lshlrev_b64 v[36:37], v123, s[74:75]
    ds_write_b128 v126, v[34:37] offset:23040
    v_cmpx_lt_u32 vcc, 3, v109
    v_lshlrev_b32 v123, 2, v69
    v_lshlrev_b32 v126, 2, v79
    v_lshlrev_b64 v[40:41], v123, s[74:75]
    ds_write_b128 v126, v[38:41] offset:23040
    v_cmpx_lt_u32 vcc, 4, v109
    s_cbranch_execz K2_SCAT_DONE
    v_lshlrev_b32 v123, 2, v70
    v_lshlrev_b32 v126, 2, v80
    v_lshlrev_b64 v[44:45], v123, s[74:75]
    ds_write_b128 v126, v[42:45] offset:23040
    v_cmpx_lt_u32 vcc, 5, v109
    s_cbranch_execz K2_SCAT_DONE
    v_lshlrev_b32 v123, 2, v71
    v_lshlrev_b32 v126, 2, v81
    v_lshlrev_b64 v[48:49], v123, s[74:75]
    ds_write_b128 v126, v[46:49] offset:23040
    v_cmpx_lt_u32 vcc, 6, v109
    s_cbranch_execz K2_SCAT_DONE
    v_lshlrev_b32 v123, 2, v72
    v_lshlrev_b32 v126, 2, v82
    v_lshlrev_b64 v[52:53], v123, s[74:75]
    ds_write_b128 v126, v[50:53] offset:23040
    v_cmpx_lt_u32 vcc, 7, v109
    s_cbranch_execz K2_SCAT_DONE
    v_lshlrev_b32 v123, 2, v73
    v_lshlrev_b32 v126, 2, v83
    v_lshlrev_b64 v[56:57], v123, s[74:75]
    ds_write_b128 v126, v[54:57] offset:23040
    v_cmpx_lt_u32 vcc, 8, v109
    s_cbranch_execz K2_SCAT_DONE
    v_lshlrev_b32 v123, 2, v74
    v_lshlrev_b32 v126, 2, v84
    v_lshlrev_b64 v[60:61], v123, s[74:75]
    ds_write_b128 v126, v[58:61] offset:23040
    v_cmpx_lt_u32 vcc, 9, v109
    s_cbranch_execz K2_SCAT_DONE
    v_lshlrev_b32 v123, 2, v75
    v_lshlrev_b32 v126, 2, v85
    v_lshlrev_b64 v[64:65], v123, s[74:75]
    ds_write_b128 v126, v[62:65] offset:23040
K2_SCAT_DONE:
    s_mov_b64 exec, -1
    s_lshl_b32 s6, s5, 2
    v_cmp_ge_u32 vcc, s6, v96
    s_and_b64 vcc, vcc, s[8:9]
    s_bcnt1_i32_b64 s7, vcc
    v_cmp_eq_u32 vcc, s6, v96
    s_and_b64 s[10:11], vcc, s[8:9]
    s_mul_i32 s28, s7, 1040
    s_add_u32 s28, s28, 85760
    s_sub_u32 s64, s28, 1040
    s_sub_u32 s7, s7, 1
    s_lshl_b32 s15, s7, 2
    s_lshr_b32 s7, s7, 2
    s_lshl_b32 s7, s7, 11
    s_add_u32 s7, s7, 54528
    v_lshlrev_b32 v124, 3, v100
    v_mul_u32_u24 v3, s7, v104
    v_lshl_add_u32 v3, v101, 4, v3
    v_add_u32 v3, 4608, v3
    v_lshrrev_b32 v122, 2, v101
    s_lshl_b32 s7, s5, 7
    s_add_u32 s7, s7, 23040
    v_lshlrev_b32 v122, 4, v122
    v_add_u32 v1, s7, v122
    v_add_u32 v7, s6, v124
    s_lshr_b32 s4, s72, 4
    s_lshl_b32 s4, s4, 2
    v_cmp_le_u32 vcc, s4, v91
    s_cmp_lg_u64 vcc, 0
    s_cselect_b32 s35, 1, 0
    s_or_b32 s35, s35, s68
    s_mov_b32 s29, -1
    s_or_b32 s12, s65, s73
    s_cmp_lg_u32 s12, 0
    s_cbranch_scc1 K2_NOSPILL
    s_cmp_eq_u32 s63, 0
    s_cbranch_scc1 K2_NOSPILL
    s_cmp_lg_u64 s[10:11], 0
    s_cbranch_scc1 K2_NOSPILL
    s_mov_b32 s29, s64
    s_mul_i32 s4, s3, 1040
    s_add_u32 s64, s4, 139840
    s_cmp_lg_u32 s35, 0
    s_cbranch_scc1 K2_NOSPILL
    v_mov_b32 v122, s15
    v_mov_b32 v123, s4
    ds_write_b32 v122, v123 offset:2048

K2_NOSPILL:
    v_mov_b32 v90, 0
    v_mov_b32 v91, 0
    v_mov_b32 v92, 0
    v_mov_b32 v93, 0
    s_sub_u32 s7, s3, 4
    s_lshl_b32 s4, s7, 2
    s_add_u32 s4, s4, 2048
    v_mov_b32 v95, s4
    s_mul_i32 s4, s7, 1040
    s_add_u32 s4, s4, 85760
    v_add_u32 v122, s4, v4
    s_mul_i32 s4, s7, 528
    s_add_u32 s4, s4, 23040
    v_lshrrev_b32 v123, 1, v4
    v_add_u32 v123, s4, v123

    v_and_b32 v94, 1, v0
    v_mul_u32_u24 v94, 0xaaaa, v94
    v_add_u32 v94, 0x4444, v94
    s_mov_b32 s62, 0
    s_mov_b32 s71, 0
    s_sub_u32 s70, s63, 5
    s_max_i32 s70, s70, 0
    s_waitcnt lgkmcnt(0)

    s_cmp_ge_u32 s3, 4
    s_cbranch_scc1 K2_NOX1
    s_mov_b32 s62, 1
    s_cmp_lt_u32 1, s63
    s_cselect_b32 s38, 12500, 0

    buffer_load_dwordx4 v[26:29], v[114:115], s[36:39], 0 idxen offen
    buffer_load_dwordx4 v[30:33], v[116:117], s[36:39], 0 idxen offen
    buffer_load_dwordx4 v[34:37], v[118:119], s[36:39], 0 idxen offen
    buffer_load_dwordx4 v[38:41], v[120:121], s[36:39], 0 idxen offen
    ds_read_b32 v114, v2 offset:64
    ds_read_b32 v116, v2 offset:72
    ds_read_b32 v118, v2 offset:80
    ds_read_b32 v120, v2 offset:88
K2_NOX1:
    s_barrier
K2_HAVEG:
    ds_read2_b32 v[50:51], v7 offset0:64 offset1:65
    ds_read2_b32 v[96:97], v95 offset0:0 offset1:12
    ds_read2_b32 v[126:127], v95 offset0:24 offset1:36
    ds_read_b32 v95, v95 offset:192
    s_mov_b64 exec, s[30:31]
    ds_read_b128 v[90:93], v1 offset:0
    s_mov_b64 exec, -1
    ds_read_b128 v[98:101], v3 offset:0
    ds_read_b128 v[102:105], v3 offset:512
    ds_read_b128 v[106:109], v3 offset:1024
    ds_read_b128 v[110:113], v3 offset:1536
    v_mov_b32 v74, 0
    v_mov_b32 v75, 0
    v_mov_b32 v76, 1.0
    v_mov_b32 v77, 1.0
    v_mov_b32 v78, 0
    v_mov_b32 v79, 0
    v_mov_b32 v80, 1.0
    v_mov_b32 v81, 1.0
    v_mov_b32 v82, 0
    v_mov_b32 v83, 0
    v_mov_b32 v84, 1.0
    v_mov_b32 v85, 1.0
    v_mov_b32 v86, 0
    v_mov_b32 v87, 0
    v_mov_b32 v88, 1.0
    v_mov_b32 v89, 1.0
    s_setprio 2
    s_waitcnt lgkmcnt(8)
    v_lshl_or_b32 v5, v51, 16, v50
    s_cmp_eq_u32 s63, 0
    v_readlane_b32 s60, v5, 0
    s_cbranch_scc1 K2_LOOPDONE
    s_and_b32 s60, s60, 0xfffffffe
    s_cmp_lg_u32 s12, 0
    s_cbranch_scc1 K2_GOSAFE
    s_waitcnt lgkmcnt(0)
    s_cmp_lg_u32 s62, 0
    s_cbranch_scc1 K2F0_MID

.p2align 6
K2F0_TOP:
    s_add_u32 s62, s62, 1
    s_cmp_lt_u32 s62, s63
    s_cselect_b32 s38, 12500, 0
    s_waitcnt lgkmcnt(0)
    s_nop 0
    buffer_load_dwordx4 v[26:29], v[114:115], s[36:39], 0 idxen offen
    buffer_load_dwordx4 v[30:33], v[116:117], s[36:39], 0 idxen offen
    buffer_load_dwordx4 v[34:37], v[118:119], s[36:39], 0 idxen offen
    buffer_load_dwordx4 v[38:41], v[120:121], s[36:39], 0 idxen offen
    ds_read_b32 v114, v2 offset:64
    ds_read_b32 v116, v2 offset:72
    ds_read_b32 v118, v2 offset:80
    ds_read_b32 v120, v2 offset:88
K2F0_MID:
    s_waitcnt vmcnt(4)
    s_nop 0
    v_lshlrev_b64 v[42:43], 16, v[10:11]
    v_lshlrev_b64 v[44:45], 16, v[12:13]
    v_lshlrev_b64 v[46:47], 16, v[14:15]
    v_lshlrev_b64 v[48:49], 16, v[16:17]
    v_lshlrev_b64 v[50:51], 16, v[18:19]
    v_lshlrev_b64 v[52:53], 16, v[20:21]
    v_lshlrev_b64 v[54:55], 16, v[22:23]
    v_lshlrev_b64 v[56:57], 16, v[24:25]
    v_smfmac_f32_32x32x32_bf16 v[10:25], v[90:93], v[106:113], v94
    s_add_u32 s4, s62, 1
    s_lshr_b32 s4, s4, 1
    v_readlane_b32 s61, v5, s4
    s_bitcmp1_b32 s60, 28
    s_nop 0
    v_smfmac_f32_32x32x32_bf16 v[42:57], v[90:93], v[98:105], v94
    s_mov_b64 exec, s[30:31]
    s_nop 0
    ds_read_b128 v[90:93], v1 offset:128
    s_mov_b64 exec, -1
    s_cbranch_scc1 K2F0_QNEW
K2F0_QBACK:
    s_bitcmp1_b32 s60, 0
    s_nop 1
    v_exp_f32 v60, v10
    v_exp_f32 v61, v11
    v_exp_f32 v64, v12
    v_exp_f32 v65, v13
    v_exp_f32 v68, v14
    v_exp_f32 v69, v15
    v_exp_f32 v72, v16
    v_exp_f32 v73, v17
    v_exp_f32 v58, v42
    v_exp_f32 v59, v43
    v_exp_f32_e64 v62, v44
    v_exp_f32 v63, v45
    s_cbranch_scc1 K2F0_STUB0
K2F0_C0:
    v_pk_fma_f32 v[74:75], v[74:75], v[58:59], v[74:75]
    v_pk_fma_f32 v[78:79], v[78:79], v[60:61], v[78:79]
    v_pk_fma_f32 v[82:83], v[82:83], v[62:63], v[82:83]
    v_pk_fma_f32 v[86:87], v[86:87], v[64:65], v[86:87]
    v_pk_fma_f32 v[74:75], v[42:43], v[76:77], v[74:75]
    v_pk_fma_f32 v[78:79], v[10:11], v[80:81], v[78:79]
    v_pk_fma_f32 v[82:83], v[44:45], v[84:85], v[82:83]
    v_pk_fma_f32 v[86:87], v[12:13], v[88:89], v[86:87]
    v_pk_fma_f32 v[76:77], v[76:77], v[58:59], v[76:77]
    v_pk_fma_f32 v[80:81], v[80:81], v[60:61], v[80:81]
    v_pk_fma_f32 v[84:85], v[84:85], v[62:63], v[84:85]
    v_pk_fma_f32 v[88:89], v[88:89], v[64:65], v[88:89]
K2F0_S1:
    s_bitcmp1_b32 s60, 1
    s_cbranch_scc1 K2F0_STUB1
K2F0_C1:
    v_exp_f32 v66, v46
    v_exp_f32 v67, v47
    v_exp_f32 v70, v48
    v_exp_f32 v71, v49
    v_pk_fma_f32 v[78:79], v[78:79], v[68:69], v[78:79]
    v_pk_fma_f32 v[86:87], v[86:87], v[72:73], v[86:87]
    v_pk_fma_f32 v[74:75], v[74:75], v[66:67], v[74:75]
    v_pk_fma_f32 v[82:83], v[82:83], v[70:71], v[82:83]
    v_pk_fma_f32 v[74:75], v[46:47], v[76:77], v[74:75]
    v_pk_fma_f32 v[78:79], v[14:15], v[80:81], v[78:79]
    v_pk_fma_f32 v[82:83], v[48:49], v[84:85], v[82:83]
    v_pk_fma_f32 v[86:87], v[16:17], v[88:89], v[86:87]
    v_pk_fma_f32 v[76:77], v[76:77], v[66:67], v[76:77]
    v_pk_fma_f32 v[80:81], v[80:81], v[68:69], v[80:81]
    v_pk_fma_f32 v[84:85], v[84:85], v[70:71], v[84:85]
    v_pk_fma_f32 v[88:89], v[88:89], v[72:73], v[88:89]
K2F0_S2:
    s_bitcmp1_b32 s60, 2
    s_cbranch_scc1 K2F0_STUB2
K2F0_C2:
    v_exp_f32 v58, v50
    v_exp_f32 v59, v51
    v_exp_f32 v60, v18
    v_exp_f32 v61, v19
    v_exp_f32 v62, v52
    v_exp_f32 v63, v53
    v_exp_f32 v64, v20
    v_exp_f32 v65, v21
    v_pk_fma_f32 v[74:75], v[74:75], v[58:59], v[74:75]
    v_pk_fma_f32 v[78:79], v[78:79], v[60:61], v[78:79]
    v_pk_fma_f32 v[82:83], v[82:83], v[62:63], v[82:83]
    v_pk_fma_f32 v[86:87], v[86:87], v[64:65], v[86:87]
    v_pk_fma_f32 v[74:75], v[50:51], v[76:77], v[74:75]
    v_pk_fma_f32 v[78:79], v[18:19], v[80:81], v[78:79]
    v_pk_fma_f32 v[82:83], v[52:53], v[84:85], v[82:83]
    v_pk_fma_f32 v[86:87], v[20:21], v[88:89], v[86:87]
    v_pk_fma_f32 v[76:77], v[76:77], v[58:59], v[76:77]
    v_pk_fma_f32 v[80:81], v[80:81], v[60:61], v[80:81]
    v_pk_fma_f32 v[84:85], v[84:85], v[62:63], v[84:85]
    v_pk_fma_f32 v[88:89], v[88:89], v[64:65], v[88:89]
K2F0_S3:
    s_bitcmp1_b32 s60, 3
    s_cbranch_scc1 K2F0_STUB3
K2F0_C3:
    v_exp_f32 v58, v54
    v_exp_f32 v59, v55
    v_exp_f32 v60, v22
    v_exp_f32 v61, v23
    v_exp_f32 v62, v56
    v_exp_f32 v63, v57
    v_exp_f32 v64, v24
    v_exp_f32 v65, v25
    v_pk_fma_f32 v[74:75], v[74:75], v[58:59], v[74:75]
    v_pk_fma_f32 v[78:79], v[78:79], v[60:61], v[78:79]
    v_pk_fma_f32 v[82:83], v[82:83], v[62:63], v[82:83]
    v_pk_fma_f32 v[86:87], v[86:87], v[64:65], v[86:87]
    v_pk_fma_f32 v[74:75], v[54:55], v[76:77], v[74:75]
    v_pk_fma_f32 v[78:79], v[22:23], v[80:81], v[78:79]
    v_pk_fma_f32 v[82:83], v[56:57], v[84:85], v[82:83]
    v_pk_fma_f32 v[86:87], v[24:25], v[88:89], v[86:87]
    v_pk_fma_f32 v[76:77], v[76:77], v[58:59], v[76:77]
    v_pk_fma_f32 v[80:81], v[80:81], v[60:61], v[80:81]
    v_pk_fma_f32 v[84:85], v[84:85], v[62:63], v[84:85]
    v_pk_fma_f32 v[88:89], v[88:89], v[64:65], v[88:89]
K2F0_S4:
    s_cmp_ge_u32 s62, s63
    s_cbranch_scc1 K2F_FIN
K2F1_TOP:
    s_add_u32 s62, s62, 1
    s_cmp_lt_u32 s62, s63
    s_cselect_b32 s38, 12500, 0
    s_waitcnt lgkmcnt(0)
    s_nop 0
    buffer_load_dwordx4 v[10:13], v[114:115], s[36:39], 0 idxen offen
    buffer_load_dwordx4 v[14:17], v[116:117], s[36:39], 0 idxen offen
    buffer_load_dwordx4 v[18:21], v[118:119], s[36:39], 0 idxen offen
    buffer_load_dwordx4 v[22:25], v[120:121], s[36:39], 0 idxen offen
    ds_read_b32 v114, v2 offset:96
    ds_read_b32 v116, v2 offset:104
    ds_read_b32 v118, v2 offset:112
    ds_read_b32 v120, v2 offset:120
K2F1_MID:
    s_waitcnt vmcnt(4)
    s_nop 0
    v_lshlrev_b64 v[42:43], 16, v[26:27]
    v_lshlrev_b64 v[44:45], 16, v[28:29]
    v_lshlrev_b64 v[46:47], 16, v[30:31]
    v_lshlrev_b64 v[48:49], 16, v[32:33]
    v_lshlrev_b64 v[50:51], 16, v[34:35]
    v_lshlrev_b64 v[52:53], 16, v[36:37]
    v_lshlrev_b64 v[54:55], 16, v[38:39]
    v_lshlrev_b64 v[56:57], 16, v[40:41]
    v_smfmac_f32_32x32x32_bf16 v[26:41], v[90:93], v[106:113], v94
    v_add_u32 v1, 256, v1
    v_add_u32_e64 v2, 64, v2
    s_bitcmp1_b32 s61, 12
    s_nop 0
    v_smfmac_f32_32x32x32_bf16 v[42:57], v[90:93], v[98:105], v94
    s_mov_b64 exec, s[30:31]
    s_nop 0
    ds_read_b128 v[90:93], v1 offset:0
    s_mov_b64 exec, -1
    s_cbranch_scc1 K2F1_QNEW
K2F1_QBACK:
    s_bitcmp1_b32 s60, 16
    s_nop 1
    v_exp_f32 v60, v26
    v_exp_f32 v61, v27
    v_exp_f32 v64, v28
    v_exp_f32 v65, v29
    v_exp_f32 v68, v30
    v_exp_f32 v69, v31
    v_exp_f32 v72, v32
    v_exp_f32 v73, v33
    v_exp_f32 v58, v42
    v_exp_f32 v59, v43
    v_exp_f32_e64 v62, v44
    v_exp_f32 v63, v45
    s_cbranch_scc1 K2F1_STUB0
K2F1_C0:
    v_pk_fma_f32 v[74:75], v[74:75], v[58:59], v[74:75]
    v_pk_fma_f32 v[78:79], v[78:79], v[60:61], v[78:79]
    v_pk_fma_f32 v[82:83], v[82:83], v[62:63], v[82:83]
    v_pk_fma_f32 v[86:87], v[86:87], v[64:65], v[86:87]
    v_pk_fma_f32 v[74:75], v[42:43], v[76:77], v[74:75]
    v_pk_fma_f32 v[78:79], v[26:27], v[80:81], v[78:79]
    v_pk_fma_f32 v[82:83], v[44:45], v[84:85], v[82:83]
    v_pk_fma_f32 v[86:87], v[28:29], v[88:89], v[86:87]
    v_pk_fma_f32 v[76:77], v[76:77], v[58:59], v[76:77]
    v_pk_fma_f32 v[80:81], v[80:81], v[60:61], v[80:81]
    v_pk_fma_f32 v[84:85], v[84:85], v[62:63], v[84:85]
    v_pk_fma_f32 v[88:89], v[88:89], v[64:65], v[88:89]
K2F1_S1:
    s_bitcmp1_b32 s60, 17
    s_cbranch_scc1 K2F1_STUB1
K2F1_C1:
    v_exp_f32 v66, v46
    v_exp_f32 v67, v47
    v_exp_f32 v70, v48
    v_exp_f32 v71, v49
    v_pk_fma_f32 v[78:79], v[78:79], v[68:69], v[78:79]
    v_pk_fma_f32 v[86:87], v[86:87], v[72:73], v[86:87]
    v_pk_fma_f32 v[74:75], v[74:75], v[66:67], v[74:75]
    v_pk_fma_f32 v[82:83], v[82:83], v[70:71], v[82:83]
    v_pk_fma_f32 v[74:75], v[46:47], v[76:77], v[74:75]
    v_pk_fma_f32 v[78:79], v[30:31], v[80:81], v[78:79]
    v_pk_fma_f32 v[82:83], v[48:49], v[84:85], v[82:83]
    v_pk_fma_f32 v[86:87], v[32:33], v[88:89], v[86:87]
    v_pk_fma_f32 v[76:77], v[76:77], v[66:67], v[76:77]
    v_pk_fma_f32 v[80:81], v[80:81], v[68:69], v[80:81]
    v_pk_fma_f32 v[84:85], v[84:85], v[70:71], v[84:85]
    v_pk_fma_f32 v[88:89], v[88:89], v[72:73], v[88:89]
K2F1_S2:
    s_bitcmp1_b32 s60, 18
    s_cbranch_scc1 K2F1_STUB2
K2F1_C2:
    v_exp_f32 v58, v50
    v_exp_f32 v59, v51
    v_exp_f32 v60, v34
    v_exp_f32 v61, v35
    v_exp_f32 v62, v52
    v_exp_f32 v63, v53
    v_exp_f32 v64, v36
    v_exp_f32 v65, v37
    v_pk_fma_f32 v[74:75], v[74:75], v[58:59], v[74:75]
    v_pk_fma_f32 v[78:79], v[78:79], v[60:61], v[78:79]
    v_pk_fma_f32 v[82:83], v[82:83], v[62:63], v[82:83]
    v_pk_fma_f32 v[86:87], v[86:87], v[64:65], v[86:87]
    v_pk_fma_f32 v[74:75], v[50:51], v[76:77], v[74:75]
    v_pk_fma_f32 v[78:79], v[34:35], v[80:81], v[78:79]
    v_pk_fma_f32 v[82:83], v[52:53], v[84:85], v[82:83]
    v_pk_fma_f32 v[86:87], v[36:37], v[88:89], v[86:87]
    v_pk_fma_f32 v[76:77], v[76:77], v[58:59], v[76:77]
    v_pk_fma_f32 v[80:81], v[80:81], v[60:61], v[80:81]
    v_pk_fma_f32 v[84:85], v[84:85], v[62:63], v[84:85]
    v_pk_fma_f32 v[88:89], v[88:89], v[64:65], v[88:89]
K2F1_S3:
    s_bitcmp1_b32 s60, 19
    s_cbranch_scc1 K2F1_STUB3
K2F1_C3:
    v_exp_f32 v58, v54
    v_exp_f32 v59, v55
    v_exp_f32 v60, v38
    v_exp_f32 v61, v39
    v_exp_f32 v62, v56
    v_exp_f32 v63, v57
    v_exp_f32 v64, v40
    v_exp_f32 v65, v41
    v_pk_fma_f32 v[74:75], v[74:75], v[58:59], v[74:75]
    v_pk_fma_f32 v[78:79], v[78:79], v[60:61], v[78:79]
    v_pk_fma_f32 v[82:83], v[82:83], v[62:63], v[82:83]
    v_pk_fma_f32 v[86:87], v[86:87], v[64:65], v[86:87]
    v_pk_fma_f32 v[74:75], v[54:55], v[76:77], v[74:75]
    v_pk_fma_f32 v[78:79], v[38:39], v[80:81], v[78:79]
    v_pk_fma_f32 v[82:83], v[56:57], v[84:85], v[82:83]
    v_pk_fma_f32 v[86:87], v[40:41], v[88:89], v[86:87]
    v_pk_fma_f32 v[76:77], v[76:77], v[58:59], v[76:77]
    v_pk_fma_f32 v[80:81], v[80:81], v[60:61], v[80:81]
    v_pk_fma_f32 v[84:85], v[84:85], v[62:63], v[84:85]
    v_pk_fma_f32 v[88:89], v[88:89], v[64:65], v[88:89]
K2F1_S4:
    s_mov_b32 s60, s61
    s_cmp_lt_u32 s62, s70
    s_cbranch_scc1 K2F0_TOP
    s_cmp_ge_u32 s62, s63
    s_cbranch_scc1 K2F_FIN
    s_cmp_eq_u32 s71, 0
    s_cbranch_scc0 K2F_PH1
    s_setprio 1
    s_mov_b32 s71, 1
    s_sub_u32 s70, s63, 2
    s_branch K2F0_TOP
K2F_PH1:
    s_setprio 0
    s_mov_b32 s70, s63
    s_branch K2F0_TOP
K2F_FIN:
    v_pk_fma_f32 v[8:9], v[76:77], v[80:81], v[8:9]
    v_pk_fma_f32 v[8:9], v[84:85], v[88:89], v[8:9]
    v_rcp_f32 v76, v76
    v_rcp_f32 v77, v77
    v_rcp_f32 v80, v80
    v_rcp_f32 v81, v81
    v_rcp_f32 v84, v84
    v_rcp_f32 v85, v85
    v_rcp_f32 v88, v88
    v_rcp_f32 v89, v89
    v_pk_mul_f32 v[74:75], v[74:75], v[76:77]
    v_pk_mul_f32 v[82:83], v[82:83], v[84:85]
    v_pk_mul_f32 v[78:79], v[78:79], v[80:81]
    v_pk_mul_f32 v[86:87], v[86:87], v[88:89]
    v_add_u32_e64 v6, s64, v4
    v_permlane32_swap_b32 v74, v82
    v_permlane32_swap_b32 v75, v83
    v_permlane32_swap_b32 v78, v86
    v_permlane32_swap_b32 v79, v87
    v_pk_add_f32 v[74:75], v[74:75], v[82:83]
    v_pk_add_f32 v[76:77], v[78:79], v[86:87]
    ds_write_b128 v6, v[74:77]
    s_branch K2_LOOPDONE
K2F0_STUB0:
    s_bitcmp0_b32 s60, 4
    s_cbranch_scc1 K2F0_RARE0
    s_nop 0
    v_pk_fma_f32 v[8:9], v[76:77], v[80:81], v[8:9]
    v_pk_fma_f32 v[8:9], v[84:85], v[88:89], v[8:9]
    v_rcp_f32 v76, v76
    v_rcp_f32 v77, v77
    v_rcp_f32 v80, v80
    v_rcp_f32 v81, v81
    v_rcp_f32 v84, v84
    v_rcp_f32 v85, v85
    v_rcp_f32 v88, v88
    v_rcp_f32 v89, v89
    v_pk_mul_f32 v[74:75], v[74:75], v[76:77]
    v_pk_mul_f32 v[82:83], v[82:83], v[84:85]
    v_pk_mul_f32 v[78:79], v[78:79], v[80:81]
    v_pk_mul_f32 v[86:87], v[86:87], v[88:89]
    v_add_u32_e64 v6, s64, v4
    v_permlane32_swap_b32 v74, v82
    v_permlane32_swap_b32 v75, v83
    v_permlane32_swap_b32 v78, v86
    v_permlane32_swap_b32 v79, v87
    v_pk_add_f32 v[74:75], v[74:75], v[82:83]
    v_pk_add_f32 v[76:77], v[78:79], v[86:87]
    ds_write_b128 v6, v[74:77]
    s_mov_b32 s64, s28
    s_nop 0
    s_add_u32 s28, s28, 1040
    s_nop 0
    s_nop 0
    v_pk_add_f32 v[76:77], v[58:59], 1.0 op_sel_hi:[1,0]
    v_pk_add_f32 v[80:81], v[60:61], 1.0 op_sel_hi:[1,0]
    v_pk_add_f32 v[84:85], v[62:63], 1.0 op_sel_hi:[1,0]
    v_pk_add_f32 v[88:89], v[64:65], 1.0 op_sel_hi:[1,0]
    v_pk_mov_b32 v[74:75], v[42:43], v[42:43] op_sel:[0,1]
    v_pk_mov_b32 v[78:79], v[10:11], v[10:11] op_sel:[0,1]
    v_pk_mov_b32 v[82:83], v[44:45], v[44:45] op_sel:[0,1]
    v_pk_mov_b32 v[86:87], v[12:13], v[12:13] op_sel:[0,1]
    s_branch K2F0_S1
K2F0_STUB1:
    s_bitcmp0_b32 s60, 5
    s_cbranch_scc1 K2F0_RARE1
    s_nop 0
    v_pk_fma_f32 v[8:9], v[76:77], v[80:81], v[8:9]
    v_pk_fma_f32 v[8:9], v[84:85], v[88:89], v[8:9]
    v_rcp_f32 v76, v76
    v_rcp_f32 v77, v77
    v_rcp_f32 v80, v80
    v_rcp_f32 v81, v81
    v_rcp_f32 v84, v84
    v_rcp_f32 v85, v85
    v_rcp_f32 v88, v88
    v_rcp_f32 v89, v89
    v_pk_mul_f32 v[74:75], v[74:75], v[76:77]
    v_pk_mul_f32 v[82:83], v[82:83], v[84:85]
    v_pk_mul_f32 v[78:79], v[78:79], v[80:81]
    v_pk_mul_f32 v[86:87], v[86:87], v[88:89]
    v_add_u32_e64 v6, s64, v4
    v_permlane32_swap_b32 v74, v82
    v_permlane32_swap_b32 v75, v83
    v_permlane32_swap_b32 v78, v86
    v_permlane32_swap_b32 v79, v87
    v_pk_add_f32 v[74:75], v[74:75], v[82:83]
    v_pk_add_f32 v[76:77], v[78:79], v[86:87]
    ds_write_b128 v6, v[74:77]
    s_mov_b32 s64, s28
    s_nop 0
    s_add_u32 s28, s28, 1040
    v_exp_f32 v66, v46
    v_exp_f32 v67, v47
    v_exp_f32 v70, v48
    v_exp_f32 v71, v49
    v_pk_add_f32 v[80:81], v[68:69], 1.0 op_sel_hi:[1,0]
    v_pk_add_f32 v[88:89], v[72:73], 1.0 op_sel_hi:[1,0]
    v_pk_add_f32 v[76:77], v[66:67], 1.0 op_sel_hi:[1,0]
    v_pk_add_f32 v[84:85], v[70:71], 1.0 op_sel_hi:[1,0]
    v_pk_mov_b32 v[74:75], v[46:47], v[46:47] op_sel:[0,1]
    v_pk_mov_b32 v[78:79], v[14:15], v[14:15] op_sel:[0,1]
    v_pk_mov_b32 v[82:83], v[48:49], v[48:49] op_sel:[0,1]
    v_pk_mov_b32 v[86:87], v[16:17], v[16:17] op_sel:[0,1]
    s_branch K2F0_S2
K2F0_STUB2:
    s_bitcmp0_b32 s60, 6
    s_cbranch_scc1 K2F0_RARE2
    s_nop 0
    v_pk_fma_f32 v[8:9], v[76:77], v[80:81], v[8:9]
    v_pk_fma_f32 v[8:9], v[84:85], v[88:89], v[8:9]
    v_rcp_f32 v76, v76
    v_rcp_f32 v77, v77
    v_rcp_f32 v80, v80
    v_rcp_f32 v81, v81
    v_rcp_f32 v84, v84
    v_rcp_f32 v85, v85
    v_rcp_f32 v88, v88
    v_rcp_f32 v89, v89
    v_pk_mul_f32 v[74:75], v[74:75], v[76:77]
    v_pk_mul_f32 v[82:83], v[82:83], v[84:85]
    v_pk_mul_f32 v[78:79], v[78:79], v[80:81]
    v_pk_mul_f32 v[86:87], v[86:87], v[88:89]
    v_add_u32_e64 v6, s64, v4
    v_permlane32_swap_b32 v74, v82
    v_permlane32_swap_b32 v75, v83
    v_permlane32_swap_b32 v78, v86
    v_permlane32_swap_b32 v79, v87
    v_pk_add_f32 v[74:75], v[74:75], v[82:83]
    v_pk_add_f32 v[76:77], v[78:79], v[86:87]
    ds_write_b128 v6, v[74:77]
    s_mov_b32 s64, s28
    s_nop 0
    s_add_u32 s28, s28, 1040
    v_exp_f32 v58, v50
    v_exp_f32 v59, v51
    v_exp_f32 v60, v18
    v_exp_f32 v61, v19
    v_exp_f32 v62, v52
    v_exp_f32 v63, v53
    v_exp_f32 v64, v20
    v_exp_f32 v65, v21
    v_pk_add_f32 v[76:77], v[58:59], 1.0 op_sel_hi:[1,0]
    v_pk_add_f32 v[80:81], v[60:61], 1.0 op_sel_hi:[1,0]
    v_pk_add_f32 v[84:85], v[62:63], 1.0 op_sel_hi:[1,0]
    v_pk_add_f32 v[88:89], v[64:65], 1.0 op_sel_hi:[1,0]
    v_pk_mov_b32 v[74:75], v[50:51], v[50:51] op_sel:[0,1]
    v_pk_mov_b32 v[78:79], v[18:19], v[18:19] op_sel:[0,1]
    v_pk_mov_b32 v[82:83], v[52:53], v[52:53] op_sel:[0,1]
    v_pk_mov_b32 v[86:87], v[20:21], v[20:21] op_sel:[0,1]
    s_branch K2F0_S3
K2F0_STUB3:
    s_bitcmp0_b32 s60, 7
    s_cbranch_scc1 K2F0_RARE3
    s_nop 0
    v_pk_fma_f32 v[8:9], v[76:77], v[80:81], v[8:9]
    v_pk_fma_f32 v[8:9], v[84:85], v[88:89], v[8:9]
    v_rcp_f32 v76, v76
    v_rcp_f32 v77, v77
    v_rcp_f32 v80, v80
    v_rcp_f32 v81, v81
    v_rcp_f32 v84, v84
    v_rcp_f32 v85, v85
    v_rcp_f32 v88, v88
    v_rcp_f32 v89, v89
    v_pk_mul_f32 v[74:75], v[74:75], v[76:77]
    v_pk_mul_f32 v[82:83], v[82:83], v[84:85]
    v_pk_mul_f32 v[78:79], v[78:79], v[80:81]
    v_pk_mul_f32 v[86:87], v[86:87], v[88:89]
    v_add_u32_e64 v6, s64, v4
    v_permlane32_swap_b32 v74, v82
    v_permlane32_swap_b32 v75, v83
    v_permlane32_swap_b32 v78, v86
    v_permlane32_swap_b32 v79, v87
    v_pk_add_f32 v[74:75], v[74:75], v[82:83]
    v_pk_add_f32 v[76:77], v[78:79], v[86:87]
    ds_write_b128 v6, v[74:77]
    s_mov_b32 s64, s28
    s_nop 0
    s_add_u32 s28, s28, 1040
    v_exp_f32 v58, v54
    v_exp_f32 v59, v55
    v_exp_f32 v60, v22
    v_exp_f32 v61, v23
    v_exp_f32 v62, v56
    v_exp_f32 v63, v57
    v_exp_f32 v64, v24
    v_exp_f32 v65, v25
    v_pk_add_f32 v[76:77], v[58:59], 1.0 op_sel_hi:[1,0]
    v_pk_add_f32 v[80:81], v[60:61], 1.0 op_sel_hi:[1,0]
    v_pk_add_f32 v[84:85], v[62:63], 1.0 op_sel_hi:[1,0]
    v_pk_add_f32 v[88:89], v[64:65], 1.0 op_sel_hi:[1,0]
    v_pk_mov_b32 v[74:75], v[54:55], v[54:55] op_sel:[0,1]
    v_pk_mov_b32 v[78:79], v[22:23], v[22:23] op_sel:[0,1]
    v_pk_mov_b32 v[82:83], v[56:57], v[56:57] op_sel:[0,1]
    v_pk_mov_b32 v[86:87], v[24:25], v[24:25] op_sel:[0,1]
    s_branch K2F0_S4
K2F0_QNEW:
    s_mov_b32 exec_lo, 0
    v_add_u32 v3, 2048, v3
    ds_read_b128 v[98:101], v3 offset:0
    ds_read_b128 v[102:105], v3 offset:512
    ds_read_b128 v[106:109], v3 offset:1024
    ds_read_b128 v[110:113], v3 offset:1536
    s_mov_b32 exec_lo, -1
    s_branch K2F0_QBACK
K2F1_STUB0:
    s_bitcmp0_b32 s60, 20
    s_cbranch_scc1 K2F1_RARE0
    v_pk_fma_f32 v[8:9], v[76:77], v[80:81], v[8:9]
    v_pk_fma_f32 v[8:9], v[84:85], v[88:89], v[8:9]
    v_rcp_f32 v76, v76
    v_rcp_f32 v77, v77
    v_rcp_f32 v80, v80
    v_rcp_f32 v81, v81
    v_rcp_f32 v84, v84
    v_rcp_f32 v85, v85
    v_rcp_f32 v88, v88
    v_rcp_f32 v89, v89
    v_pk_mul_f32 v[74:75], v[74:75], v[76:77]
    v_pk_mul_f32 v[82:83], v[82:83], v[84:85]
    v_pk_mul_f32 v[78:79], v[78:79], v[80:81]
    v_pk_mul_f32 v[86:87], v[86:87], v[88:89]
    v_add_u32_e64 v6, s64, v4
    v_permlane32_swap_b32 v74, v82
    v_permlane32_swap_b32 v75, v83
    v_permlane32_swap_b32 v78, v86
    v_permlane32_swap_b32 v79, v87
    v_pk_add_f32 v[74:75], v[74:75], v[82:83]
    v_pk_add_f32 v[76:77], v[78:79], v[86:87]
    ds_write_b128 v6, v[74:77]
    s_mov_b32 s64, s28
    s_nop 0
    s_add_u32 s28, s28, 1040
    s_nop 0
    s_nop 0
    v_pk_add_f32 v[76:77], v[58:59], 1.0 op_sel_hi:[1,0]
    v_pk_add_f32 v[80:81], v[60:61], 1.0 op_sel_hi:[1,0]
    v_pk_add_f32 v[84:85], v[62:63], 1.0 op_sel_hi:[1,0]
    v_pk_add_f32 v[88:89], v[64:65], 1.0 op_sel_hi:[1,0]
    v_pk_mov_b32 v[74:75], v[42:43], v[42:43] op_sel:[0,1]
    v_pk_mov_b32 v[78:79], v[26:27], v[26:27] op_sel:[0,1]
    v_pk_mov_b32 v[82:83], v[44:45], v[44:45] op_sel:[0,1]
    v_pk_mov_b32 v[86:87], v[28:29], v[28:29] op_sel:[0,1]
    s_branch K2F1_S1
K2F1_STUB1:
    s_bitcmp0_b32 s60, 21
    s_cbranch_scc1 K2F1_RARE1
    s_nop 0
    v_pk_fma_f32 v[8:9], v[76:77], v[80:81], v[8:9]
    v_pk_fma_f32 v[8:9], v[84:85], v[88:89], v[8:9]
    v_rcp_f32 v76, v76
    v_rcp_f32 v77, v77
    v_rcp_f32 v80, v80
    v_rcp_f32 v81, v81
    v_rcp_f32 v84, v84
    v_rcp_f32 v85, v85
    v_rcp_f32 v88, v88
    v_rcp_f32 v89, v89
    v_pk_mul_f32 v[74:75], v[74:75], v[76:77]
    v_pk_mul_f32 v[82:83], v[82:83], v[84:85]
    v_pk_mul_f32 v[78:79], v[78:79], v[80:81]
    v_pk_mul_f32 v[86:87], v[86:87], v[88:89]
    v_add_u32_e64 v6, s64, v4
    v_permlane32_swap_b32 v74, v82
    v_permlane32_swap_b32 v75, v83
    v_permlane32_swap_b32 v78, v86
    v_permlane32_swap_b32 v79, v87
    v_pk_add_f32 v[74:75], v[74:75], v[82:83]
    v_pk_add_f32 v[76:77], v[78:79], v[86:87]
    ds_write_b128 v6, v[74:77]
    s_mov_b32 s64, s28
    s_nop 0
    s_add_u32 s28, s28, 1040
    v_exp_f32 v66, v46
    v_exp_f32 v67, v47
    v_exp_f32 v70, v48
    v_exp_f32 v71, v49
    v_pk_add_f32 v[80:81], v[68:69], 1.0 op_sel_hi:[1,0]
    v_pk_add_f32 v[88:89], v[72:73], 1.0 op_sel_hi:[1,0]
    v_pk_add_f32 v[76:77], v[66:67], 1.0 op_sel_hi:[1,0]
    v_pk_add_f32 v[84:85], v[70:71], 1.0 op_sel_hi:[1,0]
    v_pk_mov_b32 v[74:75], v[46:47], v[46:47] op_sel:[0,1]
    v_pk_mov_b32 v[78:79], v[30:31], v[30:31] op_sel:[0,1]
    v_pk_mov_b32 v[82:83], v[48:49], v[48:49] op_sel:[0,1]
    v_pk_mov_b32 v[86:87], v[32:33], v[32:33] op_sel:[0,1]
    s_branch K2F1_S2
K2F1_STUB2:
    s_bitcmp0_b32 s60, 22
    s_cbranch_scc1 K2F1_RARE2
    s_nop 0
    v_pk_fma_f32 v[8:9], v[76:77], v[80:81], v[8:9]
    v_pk_fma_f32 v[8:9], v[84:85], v[88:89], v[8:9]
    v_rcp_f32 v76, v76
    v_rcp_f32 v77, v77
    v_rcp_f32 v80, v80
    v_rcp_f32 v81, v81
    v_rcp_f32 v84, v84
    v_rcp_f32 v85, v85
    v_rcp_f32 v88, v88
    v_rcp_f32 v89, v89
    v_pk_mul_f32 v[74:75], v[74:75], v[76:77]
    v_pk_mul_f32 v[82:83], v[82:83], v[84:85]
    v_pk_mul_f32 v[78:79], v[78:79], v[80:81]
    v_pk_mul_f32 v[86:87], v[86:87], v[88:89]
    v_add_u32_e64 v6, s64, v4
    v_permlane32_swap_b32 v74, v82
    v_permlane32_swap_b32 v75, v83
    v_permlane32_swap_b32 v78, v86
    v_permlane32_swap_b32 v79, v87
    v_pk_add_f32 v[74:75], v[74:75], v[82:83]
    v_pk_add_f32 v[76:77], v[78:79], v[86:87]
    ds_write_b128 v6, v[74:77]
    s_mov_b32 s64, s28
    s_nop 0
    s_add_u32 s28, s28, 1040
    v_exp_f32 v58, v50
    v_exp_f32 v59, v51
    v_exp_f32 v60, v34
    v_exp_f32 v61, v35
    v_exp_f32 v62, v52
    v_exp_f32 v63, v53
    v_exp_f32 v64, v36
    v_exp_f32 v65, v37
    v_pk_add_f32 v[76:77], v[58:59], 1.0 op_sel_hi:[1,0]
    v_pk_add_f32 v[80:81], v[60:61], 1.0 op_sel_hi:[1,0]
    v_pk_add_f32 v[84:85], v[62:63], 1.0 op_sel_hi:[1,0]
    v_pk_add_f32 v[88:89], v[64:65], 1.0 op_sel_hi:[1,0]
    v_pk_mov_b32 v[74:75], v[50:51], v[50:51] op_sel:[0,1]
    v_pk_mov_b32 v[78:79], v[34:35], v[34:35] op_sel:[0,1]
    v_pk_mov_b32 v[82:83], v[52:53], v[52:53] op_sel:[0,1]
    v_pk_mov_b32 v[86:87], v[36:37], v[36:37] op_sel:[0,1]
    s_branch K2F1_S3
K2F1_STUB3:
    s_bitcmp0_b32 s60, 23
    s_cbranch_scc1 K2F1_RARE3
    s_nop 0
    v_pk_fma_f32 v[8:9], v[76:77], v[80:81], v[8:9]
    v_pk_fma_f32 v[8:9], v[84:85], v[88:89], v[8:9]
    v_rcp_f32 v76, v76
    v_rcp_f32 v77, v77
    v_rcp_f32 v80, v80
    v_rcp_f32 v81, v81
    v_rcp_f32 v84, v84
    v_rcp_f32 v85, v85
    v_rcp_f32 v88, v88
    v_rcp_f32 v89, v89
    v_pk_mul_f32 v[74:75], v[74:75], v[76:77]
    v_pk_mul_f32 v[82:83], v[82:83], v[84:85]
    v_pk_mul_f32 v[78:79], v[78:79], v[80:81]
    v_pk_mul_f32 v[86:87], v[86:87], v[88:89]
    v_add_u32_e64 v6, s64, v4
    v_permlane32_swap_b32 v74, v82
    v_permlane32_swap_b32 v75, v83
    v_permlane32_swap_b32 v78, v86
    v_permlane32_swap_b32 v79, v87
    v_pk_add_f32 v[74:75], v[74:75], v[82:83]
    v_pk_add_f32 v[76:77], v[78:79], v[86:87]
    ds_write_b128 v6, v[74:77]
    s_mov_b32 s64, s28
    s_nop 0
    s_add_u32 s28, s28, 1040
    v_exp_f32 v58, v54
    v_exp_f32 v59, v55
    v_exp_f32 v60, v38
    v_exp_f32 v61, v39
    v_exp_f32 v62, v56
    v_exp_f32 v63, v57
    v_exp_f32 v64, v40
    v_exp_f32 v65, v41
    v_pk_add_f32 v[76:77], v[58:59], 1.0 op_sel_hi:[1,0]
    v_pk_add_f32 v[80:81], v[60:61], 1.0 op_sel_hi:[1,0]
    v_pk_add_f32 v[84:85], v[62:63], 1.0 op_sel_hi:[1,0]
    v_pk_add_f32 v[88:89], v[64:65], 1.0 op_sel_hi:[1,0]
    v_pk_mov_b32 v[74:75], v[54:55], v[54:55] op_sel:[0,1]
    v_pk_mov_b32 v[78:79], v[38:39], v[38:39] op_sel:[0,1]
    v_pk_mov_b32 v[82:83], v[56:57], v[56:57] op_sel:[0,1]
    v_pk_mov_b32 v[86:87], v[40:41], v[40:41] op_sel:[0,1]
    s_branch K2F1_S4
K2F1_QNEW:
    s_mov_b32 exec_lo, 0
    v_add_u32 v3, 2048, v3
    ds_read_b128 v[98:101], v3 offset:0
    ds_read_b128 v[102:105], v3 offset:512
    ds_read_b128 v[106:109], v3 offset:1024
    ds_read_b128 v[110:113], v3 offset:1536
    s_mov_b32 exec_lo, -1
    s_branch K2F1_QBACK
K2F0_RARE0:
    v_pk_fma_f32 v[8:9], v[76:77], v[80:81], v[8:9]
    v_pk_fma_f32 v[8:9], v[84:85], v[88:89], v[8:9]
    v_rcp_f32 v76, v76
    v_rcp_f32 v77, v77
    v_rcp_f32 v80, v80
    v_rcp_f32 v81, v81
    v_rcp_f32 v84, v84
    v_rcp_f32 v85, v85
    v_rcp_f32 v88, v88
    v_rcp_f32 v89, v89
    v_pk_mul_f32 v[74:75], v[74:75], v[76:77]
    v_pk_mul_f32 v[82:83], v[82:83], v[84:85]
    v_pk_mul_f32 v[78:79], v[78:79], v[80:81]
    v_pk_mul_f32 v[86:87], v[86:87], v[88:89]
    v_mov_b32 v76, 1.0
    v_mov_b32 v77, 1.0
    v_mov_b32 v80, 1.0
    v_mov_b32 v81, 1.0
    v_mov_b32 v84, 1.0
    v_mov_b32 v85, 1.0
    v_mov_b32_e64 v88, 1.0
    v_mov_b32 v89, 1.0
    s_branch K2F0_C0
K2F0_RARE1:
    s_bitcmp1_b32 s60, 9
    s_cbranch_scc1 K2F0_S4
    v_pk_fma_f32 v[8:9], v[76:77], v[80:81], v[8:9]
    v_pk_fma_f32 v[8:9], v[84:85], v[88:89], v[8:9]
    v_rcp_f32 v76, v76
    v_rcp_f32 v77, v77
    v_rcp_f32 v80, v80
    v_rcp_f32 v81, v81
    v_rcp_f32 v84, v84
    v_rcp_f32 v85, v85
    v_rcp_f32 v88, v88
    v_rcp_f32 v89, v89
    v_pk_mul_f32 v[74:75], v[74:75], v[76:77]
    v_pk_mul_f32 v[82:83], v[82:83], v[84:85]
    v_pk_mul_f32 v[78:79], v[78:79], v[80:81]
    v_pk_mul_f32 v[86:87], v[86:87], v[88:89]
    v_mov_b32 v76, 1.0
    v_mov_b32 v77, 1.0
    v_mov_b32 v80, 1.0
    v_mov_b32 v81, 1.0
    v_mov_b32 v84, 1.0
    v_mov_b32 v85, 1.0
    v_mov_b32_e64 v88, 1.0
    v_mov_b32 v89, 1.0
    s_branch K2F0_C1
K2F0_RARE2:
    s_bitcmp1_b32 s60, 10
    s_cbranch_scc1 K2F0_S4
    v_pk_fma_f32 v[8:9], v[76:77], v[80:81], v[8:9]
    v_pk_fma_f32 v[8:9], v[84:85], v[88:89], v[8:9]
    v_rcp_f32 v76, v76
    v_rcp_f32 v77, v77
    v_rcp_f32 v80, v80
    v_rcp_f32 v81, v81
    v_rcp_f32 v84, v84
    v_rcp_f32 v85, v85
    v_rcp_f32 v88, v88
    v_rcp_f32 v89, v89
    v_pk_mul_f32 v[74:75], v[74:75], v[76:77]
    v_pk_mul_f32 v[82:83], v[82:83], v[84:85]
    v_pk_mul_f32 v[78:79], v[78:79], v[80:81]
    v_pk_mul_f32 v[86:87], v[86:87], v[88:89]
    v_mov_b32 v76, 1.0
    v_mov_b32 v77, 1.0
    v_mov_b32 v80, 1.0
    v_mov_b32 v81, 1.0
    v_mov_b32 v84, 1.0
    v_mov_b32 v85, 1.0
    v_mov_b32_e64 v88, 1.0
    v_mov_b32 v89, 1.0
    s_branch K2F0_C2
K2F0_RARE3:
    s_bitcmp1_b32 s60, 11
    s_cbranch_scc1 K2F0_S4
    v_pk_fma_f32 v[8:9], v[76:77], v[80:81], v[8:9]
    v_pk_fma_f32 v[8:9], v[84:85], v[88:89], v[8:9]
    v_rcp_f32 v76, v76
    v_rcp_f32 v77, v77
    v_rcp_f32 v80, v80
    v_rcp_f32 v81, v81
    v_rcp_f32 v84, v84
    v_rcp_f32 v85, v85
    v_rcp_f32 v88, v88
    v_rcp_f32 v89, v89
    v_pk_mul_f32 v[74:75], v[74:75], v[76:77]
    v_pk_mul_f32 v[82:83], v[82:83], v[84:85]
    v_pk_mul_f32 v[78:79], v[78:79], v[80:81]
    v_pk_mul_f32 v[86:87], v[86:87], v[88:89]
    v_mov_b32 v76, 1.0
    v_mov_b32 v77, 1.0
    v_mov_b32 v80, 1.0
    v_mov_b32 v81, 1.0
    v_mov_b32 v84, 1.0
    v_mov_b32 v85, 1.0
    v_mov_b32_e64 v88, 1.0
    v_mov_b32 v89, 1.0
    s_branch K2F0_C3
K2F1_RARE0:
    v_pk_fma_f32 v[8:9], v[76:77], v[80:81], v[8:9]
    v_pk_fma_f32 v[8:9], v[84:85], v[88:89], v[8:9]
    v_rcp_f32 v76, v76
    v_rcp_f32 v77, v77
    v_rcp_f32 v80, v80
    v_rcp_f32 v81, v81
    v_rcp_f32 v84, v84
    v_rcp_f32 v85, v85
    v_rcp_f32 v88, v88
    v_rcp_f32 v89, v89
    v_pk_mul_f32 v[74:75], v[74:75], v[76:77]
    v_pk_mul_f32 v[82:83], v[82:83], v[84:85]
    v_pk_mul_f32 v[78:79], v[78:79], v[80:81]
    v_pk_mul_f32 v[86:87], v[86:87], v[88:89]
    v_mov_b32 v76, 1.0
    v_mov_b32 v77, 1.0
    v_mov_b32 v80, 1.0
    v_mov_b32 v81, 1.0
    v_mov_b32 v84, 1.0
    v_mov_b32 v85, 1.0
    v_mov_b32_e64 v88, 1.0
    v_mov_b32 v89, 1.0
    s_branch K2F1_C0
K2F1_RARE1:
    s_bitcmp1_b32 s60, 25
    s_cbranch_scc1 K2F1_S4
    v_pk_fma_f32 v[8:9], v[76:77], v[80:81], v[8:9]
    v_pk_fma_f32 v[8:9], v[84:85], v[88:89], v[8:9]
    v_rcp_f32 v76, v76
    v_rcp_f32 v77, v77
    v_rcp_f32 v80, v80
    v_rcp_f32 v81, v81
    v_rcp_f32 v84, v84
    v_rcp_f32 v85, v85
    v_rcp_f32 v88, v88
    v_rcp_f32 v89, v89
    v_pk_mul_f32 v[74:75], v[74:75], v[76:77]
    v_pk_mul_f32 v[82:83], v[82:83], v[84:85]
    v_pk_mul_f32 v[78:79], v[78:79], v[80:81]
    v_pk_mul_f32 v[86:87], v[86:87], v[88:89]
    v_mov_b32 v76, 1.0
    v_mov_b32 v77, 1.0
    v_mov_b32 v80, 1.0
    v_mov_b32 v81, 1.0
    v_mov_b32 v84, 1.0
    v_mov_b32 v85, 1.0
    v_mov_b32_e64 v88, 1.0
    v_mov_b32 v89, 1.0
    s_branch K2F1_C1
K2F1_RARE2:
    s_bitcmp1_b32 s60, 26
    s_cbranch_scc1 K2F1_S4
    v_pk_fma_f32 v[8:9], v[76:77], v[80:81], v[8:9]
    v_pk_fma_f32 v[8:9], v[84:85], v[88:89], v[8:9]
    v_rcp_f32 v76, v76
    v_rcp_f32 v77, v77
    v_rcp_f32 v80, v80
    v_rcp_f32 v81, v81
    v_rcp_f32 v84, v84
    v_rcp_f32 v85, v85
    v_rcp_f32 v88, v88
    v_rcp_f32 v89, v89
    v_pk_mul_f32 v[74:75], v[74:75], v[76:77]
    v_pk_mul_f32 v[82:83], v[82:83], v[84:85]
    v_pk_mul_f32 v[78:79], v[78:79], v[80:81]
    v_pk_mul_f32 v[86:87], v[86:87], v[88:89]
    v_mov_b32 v76, 1.0
    v_mov_b32 v77, 1.0
    v_mov_b32 v80, 1.0
    v_mov_b32 v81, 1.0
    v_mov_b32 v84, 1.0
    v_mov_b32 v85, 1.0
    v_mov_b32_e64 v88, 1.0
    v_mov_b32 v89, 1.0
    s_branch K2F1_C2
K2F1_RARE3:
    s_bitcmp1_b32 s60, 27
    s_cbranch_scc1 K2F1_S4
    v_pk_fma_f32 v[8:9], v[76:77], v[80:81], v[8:9]
    v_pk_fma_f32 v[8:9], v[84:85], v[88:89], v[8:9]
    v_rcp_f32 v76, v76
    v_rcp_f32 v77, v77
    v_rcp_f32 v80, v80
    v_rcp_f32 v81, v81
    v_rcp_f32 v84, v84
    v_rcp_f32 v85, v85
    v_rcp_f32 v88, v88
    v_rcp_f32 v89, v89
    v_pk_mul_f32 v[74:75], v[74:75], v[76:77]
    v_pk_mul_f32 v[82:83], v[82:83], v[84:85]
    v_pk_mul_f32 v[78:79], v[78:79], v[80:81]
    v_pk_mul_f32 v[86:87], v[86:87], v[88:89]
    v_mov_b32 v76, 1.0
    v_mov_b32 v77, 1.0
    v_mov_b32 v80, 1.0
    v_mov_b32 v81, 1.0
    v_mov_b32 v84, 1.0
    v_mov_b32 v85, 1.0
    v_mov_b32 v88, 1.0
    v_mov_b32 v89, 1.0
    s_branch K2F1_C3
K2_LOOPDONE:
    s_setprio 0
    s_mov_b32 s73, 1
    v_max_f32 v6, v8, v9
    v_mov_b32 v7, 0x6b800000
    v_cmp_nlt_f32 vcc, v6, v7
    v_cmp_u_f32 s[8:9], v8, v9
    v_add_u32 v7, 139840, v4
    s_or_b64 s[10:11], vcc, s[8:9]
    s_cmp_lt_u32 s3, 4
    s_cbranch_scc1 K2_W2
    s_waitcnt vmcnt(0) lgkmcnt(0)
    v_add_u32 v96, v96, v7
    v_add_u32 v97, v97, v7
    v_add_u32 v126, v126, v7
    v_add_u32 v127, v127, v7
    v_add_u32 v95, v95, v7

K2_EB1:
    s_barrier
    s_cmp_lg_u32 s35, 0
    s_cbranch_scc1 K2_FIXATOM

K2_CONV:
    s_cmp_lt_u32 s3, 4
    s_cbranch_scc1 K2_GEMM2

    ds_read_b128 v[10:13], v122 offset:0
    ds_read_b128 v[14:17], v96
    ds_read_b128 v[18:21], v122 offset:12480
    ds_read_b128 v[22:25], v97
    ds_read_b128 v[26:29], v122 offset:24960
    ds_read_b128 v[30:33], v126
    ds_read_b128 v[34:37], v122 offset:37440
    ds_read_b128 v[38:41], v127
    s_cmp_lg_u32 s3, 4
    s_cbranch_scc1 K2_CV3
    ds_read_b128 v[42:45], v122 offset:49920
    ds_read_b128 v[46:49], v95
    s_waitcnt lgkmcnt(0)

    v_pk_add_f32 v[42:43], v[42:43], v[46:47]
    v_pk_add_f32 v[44:45], v[44:45], v[48:49]
    v_cvt_pk_bf16_f32 v42, v42, v43
    v_cvt_pk_bf16_f32 v43, v44, v45
    ds_write_b64 v123, v[42:43] offset:25344
K2_CV3:
    s_waitcnt lgkmcnt(6)
    v_pk_add_f32 v[10:11], v[10:11], v[14:15]
    v_pk_add_f32 v[12:13], v[12:13], v[16:17]
    v_cvt_pk_bf16_f32 v10, v10, v11
    v_cvt_pk_bf16_f32 v11, v12, v13
    ds_write_b64 v123, v[10:11] offset:0
    s_waitcnt lgkmcnt(5)
    v_pk_add_f32 v[18:19], v[18:19], v[22:23]
    v_pk_add_f32 v[20:21], v[20:21], v[24:25]
    v_cvt_pk_bf16_f32 v18, v18, v19
    v_cvt_pk_bf16_f32 v19, v20, v21
    ds_write_b64 v123, v[18:19] offset:6336
    s_waitcnt lgkmcnt(4)
    v_pk_add_f32 v[26:27], v[26:27], v[30:31]
    v_pk_add_f32 v[28:29], v[28:29], v[32:33]
    v_cvt_pk_bf16_f32 v26, v26, v27
    v_cvt_pk_bf16_f32 v27, v28, v29
    ds_write_b64 v123, v[26:27] offset:12672
    s_waitcnt lgkmcnt(3)
    v_pk_add_f32 v[34:35], v[34:35], v[38:39]
    v_pk_add_f32 v[36:37], v[36:37], v[40:41]
    v_cvt_pk_bf16_f32 v34, v34, v35
    v_cvt_pk_bf16_f32 v35, v36, v37
    ds_write_b64 v123, v[34:35] offset:19008
    s_waitcnt lgkmcnt(0)
    s_barrier
    s_branch K2_NOST

K2_W2:
    s_mov_b32 s56, s20
    s_mov_b32 s57, s21
    s_mov_b32 s58, 256
    s_mov_b32 s59, 0x00020000
    s_lshr_b32 s4, s2, 3
    s_add_u32 s4, s4, s3
    s_and_b32 s4, s4, 3
    s_lshl_b32 s6, s4, 6
    s_lshl_b32 s4, s4, 14
    s_add_u32 s4, s4, 131072
    v_and_b32 v1, 31, v0
    v_and_b32 v2, 32, v0
    v_lshlrev_b32 v5, 2, v1
    v_add_u32 v5, 4096, v5
    s_waitcnt vmcnt(0) lgkmcnt(0)
    ds_read2_b32 v[126:127], v5 offset0:0 offset1:32
    buffer_load_dwordx4 v[78:81], v2, s[56:59], s6 offen
    buffer_load_dwordx4 v[82:85], v2, s[56:59], s6 offen offset:16

    buffer_load_dwordx4 v[10:13], v4, s[44:47], s4 offen offset:0
    buffer_load_dwordx4 v[14:17], v4, s[44:47], s4 offen offset:1024
    buffer_load_dwordx4 v[18:21], v4, s[44:47], s4 offen offset:2048
    buffer_load_dwordx4 v[22:25], v4, s[44:47], s4 offen offset:3072
    s_add_u32 s4, s4, 4096
    buffer_load_dwordx4 v[26:29], v4, s[44:47], s4 offen offset:0
    buffer_load_dwordx4 v[30:33], v4, s[44:47], s4 offen offset:1024
    buffer_load_dwordx4 v[34:37], v4, s[44:47], s4 offen offset:2048
    buffer_load_dwordx4 v[38:41], v4, s[44:47], s4 offen offset:3072
    s_add_u32 s4, s4, 4096
    buffer_load_dwordx4 v[42:45], v4, s[44:47], s4 offen offset:0
    buffer_load_dwordx4 v[46:49], v4, s[44:47], s4 offen offset:1024
    buffer_load_dwordx4 v[50:53], v4, s[44:47], s4 offen offset:2048
    buffer_load_dwordx4 v[54:57], v4, s[44:47], s4 offen offset:3072
    s_add_u32 s4, s4, 4096
    buffer_load_dwordx4 v[58:61], v4, s[44:47], s4 offen offset:0
    buffer_load_dwordx4 v[62:65], v4, s[44:47], s4 offen offset:1024
    buffer_load_dwordx4 v[66:69], v4, s[44:47], s4 offen offset:2048
    buffer_load_dwordx4 v[70:73], v4, s[44:47], s4 offen offset:3072
    s_add_u32 s4, s4, 4096
    v_mul_u32_u24 v3, 528, v1
    v_lshrrev_b32 v5, 1, v2
    v_add_u32 v3, v3, v5
    s_add_u32 s54, s66, s67
    s_lshl_b32 s54, s54, 8
    s_lshl_b32 s7, s66, 8
    s_add_u32 s6, s6, s7
    s_mov_b32 s4, 0xbfb8aa3b
    s_waitcnt lgkmcnt(0)
    v_cvt_f32_u32 v126, v126
    v_cvt_f32_u32 v127, v127
    v_mul_f32 v126, s4, v126
    v_mul_f32 v127, s4, v127
    s_waitcnt vmcnt(16)

    v_lshlrev_b32 v90, 16, v78
    v_and_b32 v91, 0xffff0000, v78
    v_lshlrev_b32 v92, 16, v79
    v_and_b32 v93, 0xffff0000, v79
    v_lshlrev_b32 v94, 16, v80
    v_and_b32 v95, 0xffff0000, v80
    v_lshlrev_b32 v96, 16, v81
    v_and_b32 v97, 0xffff0000, v81
    v_lshlrev_b32 v98, 16, v82
    v_and_b32 v99, 0xffff0000, v82
    v_lshlrev_b32 v100, 16, v83
    v_and_b32 v101, 0xffff0000, v83
    v_lshlrev_b32 v102, 16, v84
    v_and_b32 v103, 0xffff0000, v84
    v_lshlrev_b32 v104, 16, v85
    v_and_b32 v105, 0xffff0000, v85
    v_mul_f32 v106, v127, v90
    v_mul_f32 v90, v126, v90
    v_mul_f32 v107, v127, v91
    v_mul_f32 v91, v126, v91
    v_mul_f32 v108, v127, v92
    v_mul_f32 v92, v126, v92
    v_mul_f32 v109, v127, v93
    v_mul_f32 v93, v126, v93
    v_mul_f32 v110, v127, v94
    v_mul_f32 v94, v126, v94
    v_mul_f32 v111, v127, v95
    v_mul_f32 v95, v126, v95
    v_mul_f32 v112, v127, v96
    v_mul_f32 v96, v126, v96
    v_mul_f32 v113, v127, v97
    v_mul_f32 v97, v126, v97
    v_mul_f32 v114, v127, v98
    v_mul_f32 v98, v126, v98
    v_mul_f32 v115, v127, v99
    v_mul_f32 v99, v126, v99
    v_mul_f32 v116, v127, v100
    v_mul_f32 v100, v126, v100
    v_mul_f32 v117, v127, v101
    v_mul_f32 v101, v126, v101
    v_mul_f32 v118, v127, v102
    v_mul_f32 v102, v126, v102
    v_mul_f32 v119, v127, v103
    v_mul_f32 v103, v126, v103
    v_mul_f32 v120, v127, v104
    v_mul_f32 v104, v126, v104
    v_mul_f32 v121, v127, v105
    v_mul_f32 v105, v126, v105
    s_branch K2_EB1
K2_GEMM2:
    s_mov_b32 s4, 0xbf317218
    s_mov_b32 s5, 0xbf317218
    v_mov_b32 v126, 0
    v_mov_b32 v127, 0
    v_cmp_gt_u32 vcc, s67, v1
    s_mov_b64 s[14:15], vcc
    s_mul_i32 s7, s3, 5120
    s_add_u32 s7, s7, 85760
    v_mul_u32_u24 v6, 80, v1
    v_add3_u32 v2, v6, v2, s7
    v_bfe_u32 v6, v0, 2, 4
    v_and_b32 v7, 3, v0
    v_lshlrev_b32 v7, 4, v7
    v_lshl_add_u32 v5, v6, 8, v7
    v_mul_u32_u24 v6, 80, v6
    v_add3_u32 v4, v6, v7, s7
    v_add_u32 v1, 32, v1
    s_barrier

    ds_read_b128 v[74:77], v3 offset:23040
    ds_read_b128 v[78:81], v3 offset:39936
    ds_read_b128 v[82:85], v3 offset:23072
    ds_read_b128 v[86:89], v3 offset:39968
    s_waitcnt vmcnt(15) lgkmcnt(2)
    v_mfma_f32_32x32x16_bf16 v[90:105], v[10:13], v[74:77], v[90:105]
    ds_read_b128 v[122:125], v3 offset:23104
    v_mfma_f32_32x32x16_bf16 v[106:121], v[10:13], v[78:81], v[106:121]
    ds_read_b128 v[6:9], v3 offset:40000
    s_waitcnt vmcnt(14) lgkmcnt(2)
    v_mfma_f32_32x32x16_bf16 v[90:105], v[14:17], v[82:85], v[90:105]
    ds_read_b128 v[74:77], v3 offset:23136
    v_mfma_f32_32x32x16_bf16 v[106:121], v[14:17], v[86:89], v[106:121]
    ds_read_b128 v[78:81], v3 offset:40032
    s_waitcnt vmcnt(13) lgkmcnt(2)
    v_mfma_f32_32x32x16_bf16 v[90:105], v[18:21], v[122:125], v[90:105]
    ds_read_b128 v[82:85], v3 offset:23168
    v_mfma_f32_32x32x16_bf16 v[106:121], v[18:21], v[6:9], v[106:121]
    ds_read_b128 v[86:89], v3 offset:40064
    s_waitcnt vmcnt(12) lgkmcnt(2)
    v_mfma_f32_32x32x16_bf16 v[90:105], v[22:25], v[74:77], v[90:105]
    ds_read_b128 v[122:125], v3 offset:23200
    v_mfma_f32_32x32x16_bf16 v[106:121], v[22:25], v[78:81], v[106:121]
    ds_read_b128 v[6:9], v3 offset:40096
    s_waitcnt vmcnt(11) lgkmcnt(2)
    v_mfma_f32_32x32x16_bf16 v[90:105], v[26:29], v[82:85], v[90:105]
    ds_read_b128 v[74:77], v3 offset:23232
    v_mfma_f32_32x32x16_bf16 v[106:121], v[26:29], v[86:89], v[106:121]
    ds_read_b128 v[78:81], v3 offset:40128
    s_waitcnt vmcnt(10) lgkmcnt(2)
    v_mfma_f32_32x32x16_bf16 v[90:105], v[30:33], v[122:125], v[90:105]
    ds_read_b128 v[82:85], v3 offset:23264
    v_mfma_f32_32x32x16_bf16 v[106:121], v[30:33], v[6:9], v[106:121]
    ds_read_b128 v[86:89], v3 offset:40160
    s_waitcnt vmcnt(9) lgkmcnt(2)
    v_mfma_f32_32x32x16_bf16 v[90:105], v[34:37], v[74:77], v[90:105]
    ds_read_b128 v[122:125], v3 offset:23296
    v_mfma_f32_32x32x16_bf16 v[106:121], v[34:37], v[78:81], v[106:121]
    ds_read_b128 v[6:9], v3 offset:40192
    s_waitcnt vmcnt(8) lgkmcnt(2)
    v_mfma_f32_32x32x16_bf16 v[90:105], v[38:41], v[82:85], v[90:105]
    ds_read_b128 v[74:77], v3 offset:23328
    v_mfma_f32_32x32x16_bf16 v[106:121], v[38:41], v[86:89], v[106:121]
    ds_read_b128 v[78:81], v3 offset:40224
    s_waitcnt vmcnt(7) lgkmcnt(2)
    v_mfma_f32_32x32x16_bf16 v[90:105], v[42:45], v[122:125], v[90:105]
    ds_read_b128 v[82:85], v3 offset:23360
    v_mfma_f32_32x32x16_bf16 v[106:121], v[42:45], v[6:9], v[106:121]
    ds_read_b128 v[86:89], v3 offset:40256
    s_waitcnt vmcnt(6) lgkmcnt(2)
    v_mfma_f32_32x32x16_bf16 v[90:105], v[46:49], v[74:77], v[90:105]
    ds_read_b128 v[122:125], v3 offset:23392
    v_mfma_f32_32x32x16_bf16 v[106:121], v[46:49], v[78:81], v[106:121]
    ds_read_b128 v[6:9], v3 offset:40288
    s_waitcnt vmcnt(5) lgkmcnt(2)
    v_mfma_f32_32x32x16_bf16 v[90:105], v[50:53], v[82:85], v[90:105]
    ds_read_b128 v[74:77], v3 offset:23424
    v_mfma_f32_32x32x16_bf16 v[106:121], v[50:53], v[86:89], v[106:121]
    ds_read_b128 v[78:81], v3 offset:40320
    s_waitcnt vmcnt(4) lgkmcnt(2)
    v_mfma_f32_32x32x16_bf16 v[90:105], v[54:57], v[122:125], v[90:105]
    ds_read_b128 v[82:85], v3 offset:23456
    v_mfma_f32_32x32x16_bf16 v[106:121], v[54:57], v[6:9], v[106:121]
    ds_read_b128 v[86:89], v3 offset:40352
    s_waitcnt vmcnt(3) lgkmcnt(2)
    v_mfma_f32_32x32x16_bf16 v[90:105], v[58:61], v[74:77], v[90:105]
    ds_read_b128 v[122:125], v3 offset:23488
    v_mfma_f32_32x32x16_bf16 v[106:121], v[58:61], v[78:81], v[106:121]
    ds_read_b128 v[6:9], v3 offset:40384
    s_waitcnt vmcnt(2) lgkmcnt(2)
    v_mfma_f32_32x32x16_bf16 v[90:105], v[62:65], v[82:85], v[90:105]
    ds_read_b128 v[74:77], v3 offset:23520
    v_mfma_f32_32x32x16_bf16 v[106:121], v[62:65], v[86:89], v[106:121]
    ds_read_b128 v[78:81], v3 offset:40416
    s_waitcnt vmcnt(1) lgkmcnt(2)
    v_mfma_f32_32x32x16_bf16 v[90:105], v[66:69], v[122:125], v[90:105]
    v_mfma_f32_32x32x16_bf16 v[106:121], v[66:69], v[6:9], v[106:121]
    s_waitcnt vmcnt(0) lgkmcnt(0)
    v_mfma_f32_32x32x16_bf16 v[90:105], v[70:73], v[74:77], v[90:105]
    v_mfma_f32_32x32x16_bf16 v[106:121], v[70:73], v[78:81], v[106:121]
    v_cmp_gt_u32 vcc, s67, v1
    s_add_u32 s7, s6, 4096
    v_mov_b32 v124, 0
    v_mov_b32 v125, 0
    s_nop 6

    v_pk_mul_f32 v[90:91], v[90:91], s[4:5]
    v_cvt_pk_bf16_f32 v10, v90, v91
    v_pk_mul_f32 v[92:93], v[92:93], s[4:5]
    v_cvt_pk_bf16_f32 v11, v92, v93
    v_pk_mul_f32 v[94:95], v[94:95], s[4:5]
    v_cvt_pk_bf16_f32 v12, v94, v95
    v_pk_mul_f32 v[96:97], v[96:97], s[4:5]
    v_cvt_pk_bf16_f32 v13, v96, v97
    v_pk_mul_f32 v[98:99], v[98:99], s[4:5]
    v_cvt_pk_bf16_f32 v14, v98, v99
    v_pk_mul_f32 v[100:101], v[100:101], s[4:5]
    v_cvt_pk_bf16_f32 v15, v100, v101
    v_pk_mul_f32 v[102:103], v[102:103], s[4:5]
    v_cvt_pk_bf16_f32 v16, v102, v103
    v_pk_mul_f32 v[104:105], v[104:105], s[4:5]
    v_cvt_pk_bf16_f32 v17, v104, v105
    ds_write_b128 v2, v[10:13] offset:0
    ds_write_b128 v2, v[14:17] offset:16
    ds_read_b128 v[18:21], v4 offset:0
    ds_read_b128 v[22:25], v4 offset:1280

    v_pk_mul_f32 v[106:107], v[106:107], s[4:5]
    v_cvt_pk_bf16_f32 v26, v106, v107
    v_pk_mul_f32 v[108:109], v[108:109], s[4:5]
    v_cvt_pk_bf16_f32 v27, v108, v109
    v_pk_mul_f32 v[110:111], v[110:111], s[4:5]
    v_cvt_pk_bf16_f32 v28, v110, v111
    v_pk_mul_f32 v[112:113], v[112:113], s[4:5]
    v_cvt_pk_bf16_f32 v29, v112, v113
    v_pk_mul_f32 v[114:115], v[114:115], s[4:5]
    v_cvt_pk_bf16_f32 v30, v114, v115
    v_pk_mul_f32 v[116:117], v[116:117], s[4:5]
    v_cvt_pk_bf16_f32 v31, v116, v117
    v_pk_mul_f32 v[118:119], v[118:119], s[4:5]
    v_cvt_pk_bf16_f32 v32, v118, v119
    v_pk_mul_f32 v[120:121], v[120:121], s[4:5]
    v_cvt_pk_bf16_f32 v33, v120, v121
    ds_write_b128 v2, v[26:29] offset:2560
    ds_write_b128 v2, v[30:33] offset:2576
    ds_read_b128 v[34:37], v4 offset:2560
    ds_read_b128 v[38:41], v4 offset:3840

    s_waitcnt lgkmcnt(4)
    buffer_store_dwordx4 v[18:21], v5, s[52:55], s6 offen
    buffer_store_dwordx4 v[22:25], v5, s[52:55], s7 offen
    s_add_u32 s6, s6, 8192
    s_add_u32 s7, s7, 8192
    s_waitcnt lgkmcnt(0)
    buffer_store_dwordx4 v[34:37], v5, s[52:55], s6 offen
    buffer_store_dwordx4 v[38:41], v5, s[52:55], s7 offen

    v_pk_fma_f32 v[126:127], v[90:91], 0, v[126:127] op_sel_hi:[1,0,1]
    v_pk_fma_f32 v[126:127], v[92:93], 0, v[126:127] op_sel_hi:[1,0,1]
    v_pk_fma_f32 v[126:127], v[94:95], 0, v[126:127] op_sel_hi:[1,0,1]
    v_pk_fma_f32 v[126:127], v[96:97], 0, v[126:127] op_sel_hi:[1,0,1]
    v_pk_fma_f32 v[126:127], v[98:99], 0, v[126:127] op_sel_hi:[1,0,1]
    v_pk_fma_f32 v[126:127], v[100:101], 0, v[126:127] op_sel_hi:[1,0,1]
    v_pk_fma_f32 v[126:127], v[102:103], 0, v[126:127] op_sel_hi:[1,0,1]
    v_pk_fma_f32 v[126:127], v[104:105], 0, v[126:127] op_sel_hi:[1,0,1]
    v_pk_fma_f32 v[124:125], v[106:107], 0, v[124:125] op_sel_hi:[1,0,1]
    v_pk_fma_f32 v[124:125], v[108:109], 0, v[124:125] op_sel_hi:[1,0,1]
    v_pk_fma_f32 v[124:125], v[110:111], 0, v[124:125] op_sel_hi:[1,0,1]
    v_pk_fma_f32 v[124:125], v[112:113], 0, v[124:125] op_sel_hi:[1,0,1]
    v_pk_fma_f32 v[124:125], v[114:115], 0, v[124:125] op_sel_hi:[1,0,1]
    v_pk_fma_f32 v[124:125], v[116:117], 0, v[124:125] op_sel_hi:[1,0,1]
    v_pk_fma_f32 v[124:125], v[118:119], 0, v[124:125] op_sel_hi:[1,0,1]
    v_pk_fma_f32 v[124:125], v[120:121], 0, v[124:125] op_sel_hi:[1,0,1]
    v_cmp_u_f32 s[8:9], v126, v127
    s_and_b64 s[8:9], s[8:9], s[14:15]
    s_or_b64 s[10:11], s[10:11], s[8:9]
    v_cmp_u_f32 s[8:9], v124, v125
    s_and_b64 s[8:9], s[8:9], vcc
    s_or_b64 s[10:11], s[10:11], s[8:9]

K2_NOST:
    s_mov_b64 exec, -1
    s_cmp_lg_u32 s65, 0
    s_cbranch_scc1 K2_END
    v_mov_b32 v7, 4352
    v_mov_b32 v6, 1
    s_cmp_eq_u64 s[10:11], 0
    s_cbranch_scc1 K2_OK
    ds_write_b32 v7, v6

K2_OK:
    s_waitcnt lgkmcnt(0)
    s_barrier
    ds_read_b32 v6, v7
    s_waitcnt lgkmcnt(0)
    v_readfirstlane_b32 s4, v6
    s_cmp_eq_u32 s4, 0
    s_cbranch_scc0 K2_REDO

K2_END:
    s_endpgm
K2_REDO:
    s_mov_b32 s65, 1
    s_mov_b32 s34, 0
    v_lshlrev_b32 v6, 4, v0
    v_add_u32 v6, 85760, v6
    v_mov_b32 v12, 0
    v_mov_b32 v13, 0
    v_mov_b32 v14, 0
    v_mov_b32 v15, 0
    v_lshlrev_b32 v7, 2, v0

    ds_write_b128 v6, v[12:15] offset:0
    ds_write_b128 v6, v[12:15] offset:16384
    ds_write_b128 v6, v[12:15] offset:32768
    ds_write_b128 v6, v[12:15] offset:49152
    s_cmp_lg_u32 s3, 0
    s_cbranch_scc1 K2_NEXTROUND
    ds_write_b32 v7, v12 offset:4096

K2_NEXTROUND:
    s_waitcnt vmcnt(0) lgkmcnt(0)
    s_branch K2_ROUND

K2_FIXATOM:
    s_cmp_eq_u32 s29, -1
    s_cbranch_scc1 K2_NOFIXA
    s_mul_i32 s5, s3, 1040
    v_add_u32 v78, s5, v7
    ds_read_b128 v[74:77], v78
    v_add_u32 v79, s29, v4
    s_waitcnt lgkmcnt(0)
    ds_add_f32 v79, v74
    ds_add_f32 v79, v75 offset:4
    ds_add_f32 v79, v76 offset:8
    ds_add_f32 v79, v77 offset:12

K2_NOFIXA:
    s_cmp_lg_u32 s68, 0
    s_cbranch_scc1 K2_NEXTROUND
    s_waitcnt lgkmcnt(0)
    s_barrier
    s_branch K2_CONV

K2_TOOMANY:
    s_mov_b32 s69, 4
    s_barrier
    v_mov_b32 v90, 0
    ds_write_b32 v122, v90 offset:0
    s_waitcnt lgkmcnt(0)
    s_barrier
    s_cmp_lt_u32 s3, 8
    s_cbranch_scc1 K2_HIST
    s_branch K2_SCAN

CODE_HOT_END:
K2_GOSAFE:
    s_waitcnt lgkmcnt(0)
    s_cmp_lg_u32 s62, 0
    s_cbranch_scc1 K2S0_MID

.p2align 6
K2S0_TOP:
    s_add_u32 s62, s62, 1
    s_cmp_lt_u32 s62, s63
    s_cselect_b32 s38, 12500, 0
    s_waitcnt lgkmcnt(0)
    buffer_load_dwordx4 v[26:29], v[114:115], s[36:39], 0 idxen offen
    buffer_load_dwordx4 v[30:33], v[116:117], s[36:39], 0 idxen offen
    buffer_load_dwordx4 v[34:37], v[118:119], s[36:39], 0 idxen offen
    buffer_load_dwordx4 v[38:41], v[120:121], s[36:39], 0 idxen offen
    ds_read_b32 v114, v2 offset:64
    ds_read_b32 v116, v2 offset:72
    ds_read_b32 v118, v2 offset:80
    ds_read_b32 v120, v2 offset:88
K2S0_MID:
    s_waitcnt vmcnt(4)
    v_lshlrev_b64 v[42:43], 16, v[10:11]
    v_lshlrev_b64 v[44:45], 16, v[12:13]
    v_lshlrev_b64 v[46:47], 16, v[14:15]
    v_lshlrev_b64 v[48:49], 16, v[16:17]
    v_lshlrev_b64 v[50:51], 16, v[18:19]
    v_lshlrev_b64 v[52:53], 16, v[20:21]
    v_lshlrev_b64 v[54:55], 16, v[22:23]
    v_lshlrev_b64 v[56:57], 16, v[24:25]
    v_smfmac_f32_32x32x32_bf16 v[10:25], v[90:93], v[106:113], v94
    s_add_u32 s4, s62, 1
    s_lshr_b32 s4, s4, 1
    v_readlane_b32 s61, v5, s4
    s_bitcmp1_b32 s60, 28
    v_smfmac_f32_32x32x32_bf16 v[42:57], v[90:93], v[98:105], v94
    s_mov_b64 exec, s[30:31]
    ds_read_b128 v[90:93], v1 offset:128
    s_mov_b64 exec, -1
    s_cbranch_scc1 K2S0_QNEW
K2S0_QBACK:
    s_bitcmp1_b32 s60, 0
    s_nop 1
    v_exp_f32 v60, v10
    v_exp_f32 v61, v11
    v_exp_f32 v64, v12
    v_exp_f32 v65, v13
    v_exp_f32 v68, v14
    v_exp_f32 v69, v15
    v_exp_f32 v72, v16
    v_exp_f32 v73, v17
    v_exp_f32 v58, v42
    v_exp_f32 v59, v43
    v_exp_f32 v62, v44
    v_exp_f32 v63, v45
    s_cbranch_scc1 K2S0_STUB0
K2S0_C0:
    v_pk_add_f32 v[58:59], v[58:59], 1.0 op_sel_hi:[1,0]
    v_pk_add_f32 v[60:61], v[60:61], 1.0 op_sel_hi:[1,0]
    v_pk_add_f32 v[62:63], v[62:63], 1.0 op_sel_hi:[1,0]
    v_pk_add_f32 v[64:65], v[64:65], 1.0 op_sel_hi:[1,0]
    v_rcp_f32 v58, v58
    v_rcp_f32 v59, v59
    v_rcp_f32 v60, v60
    v_rcp_f32 v61, v61
    v_rcp_f32 v62, v62
    v_rcp_f32 v63, v63
    v_rcp_f32 v64, v64
    v_rcp_f32 v65, v65
    v_pk_fma_f32 v[74:75], v[42:43], v[58:59], v[74:75]
    v_pk_fma_f32 v[78:79], v[10:11], v[60:61], v[78:79]
    v_pk_fma_f32 v[82:83], v[44:45], v[62:63], v[82:83]
    v_pk_fma_f32 v[86:87], v[12:13], v[64:65], v[86:87]
K2S0_S1:
    s_bitcmp1_b32 s60, 1
    s_cbranch_scc1 K2S0_STUB1
K2S0_C1:
    v_exp_f32 v66, v46
    v_exp_f32 v67, v47
    v_exp_f32 v70, v48
    v_exp_f32 v71, v49
    v_pk_add_f32 v[68:69], v[68:69], 1.0 op_sel_hi:[1,0]
    v_pk_add_f32 v[72:73], v[72:73], 1.0 op_sel_hi:[1,0]
    v_pk_add_f32 v[66:67], v[66:67], 1.0 op_sel_hi:[1,0]
    v_pk_add_f32 v[70:71], v[70:71], 1.0 op_sel_hi:[1,0]
    v_rcp_f32 v66, v66
    v_rcp_f32 v67, v67
    v_rcp_f32 v68, v68
    v_rcp_f32 v69, v69
    v_rcp_f32 v70, v70
    v_rcp_f32 v71, v71
    v_rcp_f32 v72, v72
    v_rcp_f32 v73, v73
    v_pk_fma_f32 v[74:75], v[46:47], v[66:67], v[74:75]
    v_pk_fma_f32 v[78:79], v[14:15], v[68:69], v[78:79]
    v_pk_fma_f32 v[82:83], v[48:49], v[70:71], v[82:83]
    v_pk_fma_f32 v[86:87], v[16:17], v[72:73], v[86:87]
K2S0_S2:
    s_bitcmp1_b32 s60, 2
    s_cbranch_scc1 K2S0_STUB2
K2S0_C2:
    v_exp_f32 v58, v50
    v_exp_f32 v59, v51
    v_exp_f32 v60, v18
    v_exp_f32 v61, v19
    v_exp_f32 v62, v52
    v_exp_f32 v63, v53
    v_exp_f32 v64, v20
    v_exp_f32 v65, v21
    v_pk_add_f32 v[58:59], v[58:59], 1.0 op_sel_hi:[1,0]
    v_pk_add_f32 v[60:61], v[60:61], 1.0 op_sel_hi:[1,0]
    v_pk_add_f32 v[62:63], v[62:63], 1.0 op_sel_hi:[1,0]
    v_pk_add_f32 v[64:65], v[64:65], 1.0 op_sel_hi:[1,0]
    v_rcp_f32 v58, v58
    v_rcp_f32 v59, v59
    v_rcp_f32 v60, v60
    v_rcp_f32 v61, v61
    v_rcp_f32 v62, v62
    v_rcp_f32 v63, v63
    v_rcp_f32 v64, v64
    v_rcp_f32 v65, v65
    v_pk_fma_f32 v[74:75], v[50:51], v[58:59], v[74:75]
    v_pk_fma_f32 v[78:79], v[18:19], v[60:61], v[78:79]
    v_pk_fma_f32 v[82:83], v[52:53], v[62:63], v[82:83]
    v_pk_fma_f32 v[86:87], v[20:21], v[64:65], v[86:87]
K2S0_S3:
    s_bitcmp1_b32 s60, 3
    s_cbranch_scc1 K2S0_STUB3
K2S0_C3:
    v_exp_f32 v58, v54
    v_exp_f32 v59, v55
    v_exp_f32 v60, v22
    v_exp_f32 v61, v23
    v_exp_f32 v62, v56
    v_exp_f32 v63, v57
    v_exp_f32 v64, v24
    v_exp_f32 v65, v25
    v_pk_add_f32 v[58:59], v[58:59], 1.0 op_sel_hi:[1,0]
    v_pk_add_f32 v[60:61], v[60:61], 1.0 op_sel_hi:[1,0]
    v_pk_add_f32 v[62:63], v[62:63], 1.0 op_sel_hi:[1,0]
    v_pk_add_f32 v[64:65], v[64:65], 1.0 op_sel_hi:[1,0]
    v_rcp_f32 v58, v58
    v_rcp_f32 v59, v59
    v_rcp_f32 v60, v60
    v_rcp_f32 v61, v61
    v_rcp_f32 v62, v62
    v_rcp_f32 v63, v63
    v_rcp_f32 v64, v64
    v_rcp_f32 v65, v65
    v_pk_fma_f32 v[74:75], v[54:55], v[58:59], v[74:75]
    v_pk_fma_f32 v[78:79], v[22:23], v[60:61], v[78:79]
    v_pk_fma_f32 v[82:83], v[56:57], v[62:63], v[82:83]
    v_pk_fma_f32 v[86:87], v[24:25], v[64:65], v[86:87]
K2S0_S4:
    s_cmp_ge_u32 s62, s63
    s_cbranch_scc1 K2S_FIN
K2S1_TOP:
    s_add_u32 s62, s62, 1
    s_cmp_lt_u32 s62, s63
    s_cselect_b32 s38, 12500, 0
    s_waitcnt lgkmcnt(0)
    buffer_load_dwordx4 v[10:13], v[114:115], s[36:39], 0 idxen offen
    buffer_load_dwordx4 v[14:17], v[116:117], s[36:39], 0 idxen offen
    buffer_load_dwordx4 v[18:21], v[118:119], s[36:39], 0 idxen offen
    buffer_load_dwordx4 v[22:25], v[120:121], s[36:39], 0 idxen offen
    ds_read_b32 v114, v2 offset:96
    ds_read_b32 v116, v2 offset:104
    ds_read_b32 v118, v2 offset:112
    ds_read_b32 v120, v2 offset:120
K2S1_MID:
    s_waitcnt vmcnt(4)
    v_lshlrev_b64 v[42:43], 16, v[26:27]
    v_lshlrev_b64 v[44:45], 16, v[28:29]
    v_lshlrev_b64 v[46:47], 16, v[30:31]
    v_lshlrev_b64 v[48:49], 16, v[32:33]
    v_lshlrev_b64 v[50:51], 16, v[34:35]
    v_lshlrev_b64 v[52:53], 16, v[36:37]
    v_lshlrev_b64 v[54:55], 16, v[38:39]
    v_lshlrev_b64 v[56:57], 16, v[40:41]
    v_smfmac_f32_32x32x32_bf16 v[26:41], v[90:93], v[106:113], v94
    v_add_u32 v1, 256, v1
    v_add_u32 v2, 64, v2
    s_bitcmp1_b32 s61, 12
    s_nop 0
    v_smfmac_f32_32x32x32_bf16 v[42:57], v[90:93], v[98:105], v94
    s_mov_b64 exec, s[30:31]
    ds_read_b128 v[90:93], v1 offset:0
    s_mov_b64 exec, -1
    s_cbranch_scc1 K2S1_QNEW
K2S1_QBACK:
    s_bitcmp1_b32 s60, 16
    s_nop 1
    v_exp_f32 v60, v26
    v_exp_f32 v61, v27
    v_exp_f32 v64, v28
    v_exp_f32 v65, v29
    v_exp_f32 v68, v30
    v_exp_f32 v69, v31
    v_exp_f32 v72, v32
    v_exp_f32 v73, v33
    v_exp_f32 v58, v42
    v_exp_f32 v59, v43
    v_exp_f32 v62, v44
    v_exp_f32 v63, v45
    s_cbranch_scc1 K2S1_STUB0
K2S1_C0:
    v_pk_add_f32 v[58:59], v[58:59], 1.0 op_sel_hi:[1,0]
    v_pk_add_f32 v[60:61], v[60:61], 1.0 op_sel_hi:[1,0]
    v_pk_add_f32 v[62:63], v[62:63], 1.0 op_sel_hi:[1,0]
    v_pk_add_f32 v[64:65], v[64:65], 1.0 op_sel_hi:[1,0]
    v_rcp_f32 v58, v58
    v_rcp_f32 v59, v59
    v_rcp_f32 v60, v60
    v_rcp_f32 v61, v61
    v_rcp_f32 v62, v62
    v_rcp_f32 v63, v63
    v_rcp_f32 v64, v64
    v_rcp_f32 v65, v65
    v_pk_fma_f32 v[74:75], v[42:43], v[58:59], v[74:75]
    v_pk_fma_f32 v[78:79], v[26:27], v[60:61], v[78:79]
    v_pk_fma_f32 v[82:83], v[44:45], v[62:63], v[82:83]
    v_pk_fma_f32 v[86:87], v[28:29], v[64:65], v[86:87]
K2S1_S1:
    s_bitcmp1_b32 s60, 17
    s_cbranch_scc1 K2S1_STUB1
K2S1_C1:
    v_exp_f32 v66, v46
    v_exp_f32 v67, v47
    v_exp_f32 v70, v48
    v_exp_f32 v71, v49
    v_pk_add_f32 v[68:69], v[68:69], 1.0 op_sel_hi:[1,0]
    v_pk_add_f32 v[72:73], v[72:73], 1.0 op_sel_hi:[1,0]
    v_pk_add_f32 v[66:67], v[66:67], 1.0 op_sel_hi:[1,0]
    v_pk_add_f32 v[70:71], v[70:71], 1.0 op_sel_hi:[1,0]
    v_rcp_f32 v66, v66
    v_rcp_f32 v67, v67
    v_rcp_f32 v68, v68
    v_rcp_f32 v69, v69
    v_rcp_f32 v70, v70
    v_rcp_f32 v71, v71
    v_rcp_f32 v72, v72
    v_rcp_f32 v73, v73
    v_pk_fma_f32 v[74:75], v[46:47], v[66:67], v[74:75]
    v_pk_fma_f32 v[78:79], v[30:31], v[68:69], v[78:79]
    v_pk_fma_f32 v[82:83], v[48:49], v[70:71], v[82:83]
    v_pk_fma_f32 v[86:87], v[32:33], v[72:73], v[86:87]
K2S1_S2:
    s_bitcmp1_b32 s60, 18
    s_cbranch_scc1 K2S1_STUB2
K2S1_C2:
    v_exp_f32 v58, v50
    v_exp_f32 v59, v51
    v_exp_f32 v60, v34
    v_exp_f32 v61, v35
    v_exp_f32 v62, v52
    v_exp_f32 v63, v53
    v_exp_f32 v64, v36
    v_exp_f32 v65, v37
    v_pk_add_f32 v[58:59], v[58:59], 1.0 op_sel_hi:[1,0]
    v_pk_add_f32 v[60:61], v[60:61], 1.0 op_sel_hi:[1,0]
    v_pk_add_f32 v[62:63], v[62:63], 1.0 op_sel_hi:[1,0]
    v_pk_add_f32 v[64:65], v[64:65], 1.0 op_sel_hi:[1,0]
    v_rcp_f32 v58, v58
    v_rcp_f32 v59, v59
    v_rcp_f32 v60, v60
    v_rcp_f32 v61, v61
    v_rcp_f32 v62, v62
    v_rcp_f32 v63, v63
    v_rcp_f32 v64, v64
    v_rcp_f32 v65, v65
    v_pk_fma_f32 v[74:75], v[50:51], v[58:59], v[74:75]
    v_pk_fma_f32 v[78:79], v[34:35], v[60:61], v[78:79]
    v_pk_fma_f32 v[82:83], v[52:53], v[62:63], v[82:83]
    v_pk_fma_f32 v[86:87], v[36:37], v[64:65], v[86:87]
K2S1_S3:
    s_bitcmp1_b32 s60, 19
    s_cbranch_scc1 K2S1_STUB3
K2S1_C3:
    v_exp_f32 v58, v54
    v_exp_f32 v59, v55
    v_exp_f32 v60, v38
    v_exp_f32 v61, v39
    v_exp_f32 v62, v56
    v_exp_f32 v63, v57
    v_exp_f32 v64, v40
    v_exp_f32 v65, v41
    v_pk_add_f32 v[58:59], v[58:59], 1.0 op_sel_hi:[1,0]
    v_pk_add_f32 v[60:61], v[60:61], 1.0 op_sel_hi:[1,0]
    v_pk_add_f32 v[62:63], v[62:63], 1.0 op_sel_hi:[1,0]
    v_pk_add_f32 v[64:65], v[64:65], 1.0 op_sel_hi:[1,0]
    v_rcp_f32 v58, v58
    v_rcp_f32 v59, v59
    v_rcp_f32 v60, v60
    v_rcp_f32 v61, v61
    v_rcp_f32 v62, v62
    v_rcp_f32 v63, v63
    v_rcp_f32 v64, v64
    v_rcp_f32 v65, v65
    v_pk_fma_f32 v[74:75], v[54:55], v[58:59], v[74:75]
    v_pk_fma_f32 v[78:79], v[38:39], v[60:61], v[78:79]
    v_pk_fma_f32 v[82:83], v[56:57], v[62:63], v[82:83]
    v_pk_fma_f32 v[86:87], v[40:41], v[64:65], v[86:87]
K2S1_S4:
    s_mov_b32 s60, s61
    s_cmp_lt_u32 s62, s70
    s_cbranch_scc1 K2S0_TOP
    s_cmp_ge_u32 s62, s63
    s_cbranch_scc1 K2S_FIN
    s_cmp_eq_u32 s71, 0
    s_cbranch_scc0 K2S_PH1
    s_setprio 1
    s_mov_b32 s71, 1
    s_sub_u32 s70, s63, 2
    s_branch K2S0_TOP
K2S_PH1:
    s_setprio 0
    s_mov_b32 s70, s63
    s_branch K2S0_TOP
K2S_FIN:
    v_add_u32 v6, s64, v4
    s_nop 0
    v_permlane32_swap_b32 v74, v82
    v_permlane32_swap_b32 v75, v83
    v_permlane32_swap_b32 v78, v86
    v_permlane32_swap_b32 v79, v87
    v_pk_add_f32 v[74:75], v[74:75], v[82:83]
    v_pk_add_f32 v[76:77], v[78:79], v[86:87]
    ds_add_f32 v6, v74 offset:0
    ds_add_f32 v6, v75 offset:4
    ds_add_f32 v6, v76 offset:8
    ds_add_f32 v6, v77 offset:12
    s_branch K2_LOOPDONE
K2S0_STUB0:
    s_bitcmp0_b32 s60, 4
    s_cbranch_scc1 K2S0_RARE0
    v_add_u32 v6, s64, v4
    s_nop 0
    v_permlane32_swap_b32 v74, v82
    v_permlane32_swap_b32 v75, v83
    v_permlane32_swap_b32 v78, v86
    v_permlane32_swap_b32 v79, v87
    v_pk_add_f32 v[74:75], v[74:75], v[82:83]
    v_pk_add_f32 v[76:77], v[78:79], v[86:87]
    ds_add_f32 v6, v74 offset:0
    ds_add_f32 v6, v75 offset:4
    ds_add_f32 v6, v76 offset:8
    ds_add_f32 v6, v77 offset:12
    s_mov_b32 s64, s28
    s_add_u32 s28, s28, 1040
    s_nop 0
    v_pk_add_f32 v[58:59], v[58:59], 1.0 op_sel_hi:[1,0]
    v_pk_add_f32 v[60:61], v[60:61], 1.0 op_sel_hi:[1,0]
    v_pk_add_f32 v[62:63], v[62:63], 1.0 op_sel_hi:[1,0]
    v_pk_add_f32 v[64:65], v[64:65], 1.0 op_sel_hi:[1,0]
    v_rcp_f32 v58, v58
    v_rcp_f32 v59, v59
    v_rcp_f32 v60, v60
    v_rcp_f32 v61, v61
    v_rcp_f32 v62, v62
    v_rcp_f32 v63, v63
    v_rcp_f32 v64, v64
    v_rcp_f32 v65, v65
    v_pk_mul_f32 v[74:75], v[42:43], v[58:59]
    v_pk_mul_f32 v[78:79], v[10:11], v[60:61]
    v_pk_mul_f32 v[82:83], v[44:45], v[62:63]
    v_pk_mul_f32 v[86:87], v[12:13], v[64:65]
    s_branch K2S0_S1
K2S0_STUB1:
    s_bitcmp0_b32 s60, 5
    s_cbranch_scc1 K2S0_RARE1
    v_add_u32 v6, s64, v4
    s_nop 0
    v_permlane32_swap_b32 v74, v82
    v_permlane32_swap_b32 v75, v83
    v_permlane32_swap_b32 v78, v86
    v_permlane32_swap_b32 v79, v87
    v_pk_add_f32 v[74:75], v[74:75], v[82:83]
    v_pk_add_f32 v[76:77], v[78:79], v[86:87]
    ds_add_f32 v6, v74 offset:0
    ds_add_f32 v6, v75 offset:4
    ds_add_f32 v6, v76 offset:8
    ds_add_f32 v6, v77 offset:12
    s_mov_b32 s64, s28
    s_add_u32 s28, s28, 1040
    v_exp_f32 v66, v46
    v_exp_f32 v67, v47
    v_exp_f32 v70, v48
    v_exp_f32 v71, v49
    v_pk_add_f32 v[68:69], v[68:69], 1.0 op_sel_hi:[1,0]
    v_pk_add_f32 v[72:73], v[72:73], 1.0 op_sel_hi:[1,0]
    v_pk_add_f32 v[66:67], v[66:67], 1.0 op_sel_hi:[1,0]
    v_pk_add_f32 v[70:71], v[70:71], 1.0 op_sel_hi:[1,0]
    v_rcp_f32 v66, v66
    v_rcp_f32 v67, v67
    v_rcp_f32 v68, v68
    v_rcp_f32 v69, v69
    v_rcp_f32 v70, v70
    v_rcp_f32 v71, v71
    v_rcp_f32 v72, v72
    v_rcp_f32 v73, v73
    v_pk_mul_f32 v[74:75], v[46:47], v[66:67]
    v_pk_mul_f32 v[78:79], v[14:15], v[68:69]
    v_pk_mul_f32 v[82:83], v[48:49], v[70:71]
    v_pk_mul_f32 v[86:87], v[16:17], v[72:73]
    s_branch K2S0_S2
K2S0_STUB2:
    s_bitcmp0_b32 s60, 6
    s_cbranch_scc1 K2S0_RARE2
    v_add_u32 v6, s64, v4
    s_nop 0
    v_permlane32_swap_b32 v74, v82
    v_permlane32_swap_b32 v75, v83
    v_permlane32_swap_b32 v78, v86
    v_permlane32_swap_b32 v79, v87
    v_pk_add_f32 v[74:75], v[74:75], v[82:83]
    v_pk_add_f32 v[76:77], v[78:79], v[86:87]
    ds_add_f32 v6, v74 offset:0
    ds_add_f32 v6, v75 offset:4
    ds_add_f32 v6, v76 offset:8
    ds_add_f32 v6, v77 offset:12
    s_mov_b32 s64, s28
    s_add_u32 s28, s28, 1040
    v_exp_f32 v58, v50
    v_exp_f32 v59, v51
    v_exp_f32 v60, v18
    v_exp_f32 v61, v19
    v_exp_f32 v62, v52
    v_exp_f32 v63, v53
    v_exp_f32 v64, v20
    v_exp_f32 v65, v21
    v_pk_add_f32 v[58:59], v[58:59], 1.0 op_sel_hi:[1,0]
    v_pk_add_f32 v[60:61], v[60:61], 1.0 op_sel_hi:[1,0]
    v_pk_add_f32 v[62:63], v[62:63], 1.0 op_sel_hi:[1,0]
    v_pk_add_f32 v[64:65], v[64:65], 1.0 op_sel_hi:[1,0]
    v_rcp_f32 v58, v58
    v_rcp_f32 v59, v59
    v_rcp_f32 v60, v60
    v_rcp_f32 v61, v61
    v_rcp_f32 v62, v62
    v_rcp_f32 v63, v63
    v_rcp_f32 v64, v64
    v_rcp_f32 v65, v65
    v_pk_mul_f32 v[74:75], v[50:51], v[58:59]
    v_pk_mul_f32 v[78:79], v[18:19], v[60:61]
    v_pk_mul_f32 v[82:83], v[52:53], v[62:63]
    v_pk_mul_f32 v[86:87], v[20:21], v[64:65]
    s_branch K2S0_S3
K2S0_STUB3:
    s_bitcmp0_b32 s60, 7
    s_cbranch_scc1 K2S0_RARE3
    v_add_u32 v6, s64, v4
    s_nop 0
    v_permlane32_swap_b32 v74, v82
    v_permlane32_swap_b32 v75, v83
    v_permlane32_swap_b32 v78, v86
    v_permlane32_swap_b32 v79, v87
    v_pk_add_f32 v[74:75], v[74:75], v[82:83]
    v_pk_add_f32 v[76:77], v[78:79], v[86:87]
    ds_add_f32 v6, v74 offset:0
    ds_add_f32 v6, v75 offset:4
    ds_add_f32 v6, v76 offset:8
    ds_add_f32 v6, v77 offset:12
    s_mov_b32 s64, s28
    s_add_u32 s28, s28, 1040
    v_exp_f32 v58, v54
    v_exp_f32 v59, v55
    v_exp_f32 v60, v22
    v_exp_f32 v61, v23
    v_exp_f32 v62, v56
    v_exp_f32 v63, v57
    v_exp_f32 v64, v24
    v_exp_f32 v65, v25
    v_pk_add_f32 v[58:59], v[58:59], 1.0 op_sel_hi:[1,0]
    v_pk_add_f32 v[60:61], v[60:61], 1.0 op_sel_hi:[1,0]
    v_pk_add_f32 v[62:63], v[62:63], 1.0 op_sel_hi:[1,0]
    v_pk_add_f32 v[64:65], v[64:65], 1.0 op_sel_hi:[1,0]
    v_rcp_f32 v58, v58
    v_rcp_f32 v59, v59
    v_rcp_f32 v60, v60
    v_rcp_f32 v61, v61
    v_rcp_f32 v62, v62
    v_rcp_f32 v63, v63
    v_rcp_f32 v64, v64
    v_rcp_f32 v65, v65
    v_pk_mul_f32 v[74:75], v[54:55], v[58:59]
    v_pk_mul_f32 v[78:79], v[22:23], v[60:61]
    v_pk_mul_f32 v[82:83], v[56:57], v[62:63]
    v_pk_mul_f32 v[86:87], v[24:25], v[64:65]
    s_branch K2S0_S4
K2S0_QNEW:
    s_mov_b32 exec_lo, 0
    v_add_u32 v3, 2048, v3
    ds_read_b128 v[98:101], v3 offset:0
    ds_read_b128 v[102:105], v3 offset:512
    ds_read_b128 v[106:109], v3 offset:1024
    ds_read_b128 v[110:113], v3 offset:1536
    s_mov_b32 exec_lo, -1
    s_branch K2S0_QBACK
K2S1_STUB0:
    s_bitcmp0_b32 s60, 20
    s_cbranch_scc1 K2S1_RARE0
    v_add_u32 v6, s64, v4
    s_nop 0
    v_permlane32_swap_b32 v74, v82
    v_permlane32_swap_b32 v75, v83
    v_permlane32_swap_b32 v78, v86
    v_permlane32_swap_b32 v79, v87
    v_pk_add_f32 v[74:75], v[74:75], v[82:83]
    v_pk_add_f32 v[76:77], v[78:79], v[86:87]
    ds_add_f32 v6, v74 offset:0
    ds_add_f32 v6, v75 offset:4
    ds_add_f32 v6, v76 offset:8
    ds_add_f32 v6, v77 offset:12
    s_mov_b32 s64, s28
    s_add_u32 s28, s28, 1040
    s_nop 0
    v_pk_add_f32 v[58:59], v[58:59], 1.0 op_sel_hi:[1,0]
    v_pk_add_f32 v[60:61], v[60:61], 1.0 op_sel_hi:[1,0]
    v_pk_add_f32 v[62:63], v[62:63], 1.0 op_sel_hi:[1,0]
    v_pk_add_f32 v[64:65], v[64:65], 1.0 op_sel_hi:[1,0]
    v_rcp_f32 v58, v58
    v_rcp_f32 v59, v59
    v_rcp_f32 v60, v60
    v_rcp_f32 v61, v61
    v_rcp_f32 v62, v62
    v_rcp_f32 v63, v63
    v_rcp_f32 v64, v64
    v_rcp_f32 v65, v65
    v_pk_mul_f32 v[74:75], v[42:43], v[58:59]
    v_pk_mul_f32 v[78:79], v[26:27], v[60:61]
    v_pk_mul_f32 v[82:83], v[44:45], v[62:63]
    v_pk_mul_f32 v[86:87], v[28:29], v[64:65]
    s_branch K2S1_S1
K2S1_STUB1:
    s_bitcmp0_b32 s60, 21
    s_cbranch_scc1 K2S1_RARE1
    v_add_u32 v6, s64, v4
    s_nop 0
    v_permlane32_swap_b32 v74, v82
    v_permlane32_swap_b32 v75, v83
    v_permlane32_swap_b32 v78, v86
    v_permlane32_swap_b32 v79, v87
    v_pk_add_f32 v[74:75], v[74:75], v[82:83]
    v_pk_add_f32 v[76:77], v[78:79], v[86:87]
    ds_add_f32 v6, v74 offset:0
    ds_add_f32 v6, v75 offset:4
    ds_add_f32 v6, v76 offset:8
    ds_add_f32 v6, v77 offset:12
    s_mov_b32 s64, s28
    s_add_u32 s28, s28, 1040
    v_exp_f32 v66, v46
    v_exp_f32 v67, v47
    v_exp_f32 v70, v48
    v_exp_f32 v71, v49
    v_pk_add_f32 v[68:69], v[68:69], 1.0 op_sel_hi:[1,0]
    v_pk_add_f32 v[72:73], v[72:73], 1.0 op_sel_hi:[1,0]
    v_pk_add_f32 v[66:67], v[66:67], 1.0 op_sel_hi:[1,0]
    v_pk_add_f32 v[70:71], v[70:71], 1.0 op_sel_hi:[1,0]
    v_rcp_f32 v66, v66
    v_rcp_f32 v67, v67
    v_rcp_f32 v68, v68
    v_rcp_f32 v69, v69
    v_rcp_f32 v70, v70
    v_rcp_f32 v71, v71
    v_rcp_f32 v72, v72
    v_rcp_f32 v73, v73
    v_pk_mul_f32 v[74:75], v[46:47], v[66:67]
    v_pk_mul_f32 v[78:79], v[30:31], v[68:69]
    v_pk_mul_f32 v[82:83], v[48:49], v[70:71]
    v_pk_mul_f32 v[86:87], v[32:33], v[72:73]
    s_branch K2S1_S2
K2S1_STUB2:
    s_bitcmp0_b32 s60, 22
    s_cbranch_scc1 K2S1_RARE2
    v_add_u32 v6, s64, v4
    s_nop 0
    v_permlane32_swap_b32 v74, v82
    v_permlane32_swap_b32 v75, v83
    v_permlane32_swap_b32 v78, v86
    v_permlane32_swap_b32 v79, v87
    v_pk_add_f32 v[74:75], v[74:75], v[82:83]
    v_pk_add_f32 v[76:77], v[78:79], v[86:87]
    ds_add_f32 v6, v74 offset:0
    ds_add_f32 v6, v75 offset:4
    ds_add_f32 v6, v76 offset:8
    ds_add_f32 v6, v77 offset:12
    s_mov_b32 s64, s28
    s_add_u32 s28, s28, 1040
    v_exp_f32 v58, v50
    v_exp_f32 v59, v51
    v_exp_f32 v60, v34
    v_exp_f32 v61, v35
    v_exp_f32 v62, v52
    v_exp_f32 v63, v53
    v_exp_f32 v64, v36
    v_exp_f32 v65, v37
    v_pk_add_f32 v[58:59], v[58:59], 1.0 op_sel_hi:[1,0]
    v_pk_add_f32 v[60:61], v[60:61], 1.0 op_sel_hi:[1,0]
    v_pk_add_f32 v[62:63], v[62:63], 1.0 op_sel_hi:[1,0]
    v_pk_add_f32 v[64:65], v[64:65], 1.0 op_sel_hi:[1,0]
    v_rcp_f32 v58, v58
    v_rcp_f32 v59, v59
    v_rcp_f32 v60, v60
    v_rcp_f32 v61, v61
    v_rcp_f32 v62, v62
    v_rcp_f32 v63, v63
    v_rcp_f32 v64, v64
    v_rcp_f32 v65, v65
    v_pk_mul_f32 v[74:75], v[50:51], v[58:59]
    v_pk_mul_f32 v[78:79], v[34:35], v[60:61]
    v_pk_mul_f32 v[82:83], v[52:53], v[62:63]
    v_pk_mul_f32 v[86:87], v[36:37], v[64:65]
    s_branch K2S1_S3
K2S1_STUB3:
    s_bitcmp0_b32 s60, 23
    s_cbranch_scc1 K2S1_RARE3
    v_add_u32 v6, s64, v4
    s_nop 0
    v_permlane32_swap_b32 v74, v82
    v_permlane32_swap_b32 v75, v83
    v_permlane32_swap_b32 v78, v86
    v_permlane32_swap_b32 v79, v87
    v_pk_add_f32 v[74:75], v[74:75], v[82:83]
    v_pk_add_f32 v[76:77], v[78:79], v[86:87]
    ds_add_f32 v6, v74 offset:0
    ds_add_f32 v6, v75 offset:4
    ds_add_f32 v6, v76 offset:8
    ds_add_f32 v6, v77 offset:12
    s_mov_b32 s64, s28
    s_add_u32 s28, s28, 1040
    v_exp_f32 v58, v54
    v_exp_f32 v59, v55
    v_exp_f32 v60, v38
    v_exp_f32 v61, v39
    v_exp_f32 v62, v56
    v_exp_f32 v63, v57
    v_exp_f32 v64, v40
    v_exp_f32 v65, v41
    v_pk_add_f32 v[58:59], v[58:59], 1.0 op_sel_hi:[1,0]
    v_pk_add_f32 v[60:61], v[60:61], 1.0 op_sel_hi:[1,0]
    v_pk_add_f32 v[62:63], v[62:63], 1.0 op_sel_hi:[1,0]
    v_pk_add_f32 v[64:65], v[64:65], 1.0 op_sel_hi:[1,0]
    v_rcp_f32 v58, v58
    v_rcp_f32 v59, v59
    v_rcp_f32 v60, v60
    v_rcp_f32 v61, v61
    v_rcp_f32 v62, v62
    v_rcp_f32 v63, v63
    v_rcp_f32 v64, v64
    v_rcp_f32 v65, v65
    v_pk_mul_f32 v[74:75], v[54:55], v[58:59]
    v_pk_mul_f32 v[78:79], v[38:39], v[60:61]
    v_pk_mul_f32 v[82:83], v[56:57], v[62:63]
    v_pk_mul_f32 v[86:87], v[40:41], v[64:65]
    s_branch K2S1_S4
K2S1_QNEW:
    s_mov_b32 exec_lo, 0
    v_add_u32 v3, 2048, v3
    ds_read_b128 v[98:101], v3 offset:0
    ds_read_b128 v[102:105], v3 offset:512
    ds_read_b128 v[106:109], v3 offset:1024
    ds_read_b128 v[110:113], v3 offset:1536
    s_mov_b32 exec_lo, -1
    s_branch K2S1_QBACK
K2S0_RARE0:
    s_branch K2S0_C0
K2S0_RARE1:
    s_bitcmp1_b32 s60, 9
    s_cbranch_scc1 K2S0_S4
    s_branch K2S0_C1
K2S0_RARE2:
    s_bitcmp1_b32 s60, 10
    s_cbranch_scc1 K2S0_S4
    s_branch K2S0_C2
K2S0_RARE3:
    s_bitcmp1_b32 s60, 11
    s_cbranch_scc1 K2S0_S4
    s_branch K2S0_C3
K2S1_RARE0:
    s_branch K2S1_C0
K2S1_RARE1:
    s_bitcmp1_b32 s60, 25
    s_cbranch_scc1 K2S1_S4
    s_branch K2S1_C1
K2S1_RARE2:
    s_bitcmp1_b32 s60, 26
    s_cbranch_scc1 K2S1_S4
    s_branch K2S1_C2
K2S1_RARE3:
    s_bitcmp1_b32 s60, 27
    s_cbranch_scc1 K2S1_S4
    s_branch K2S1_C3
CODE_END:
.section .rodata,"a"
.p2align 6
.amdhsa_kernel k1_kernel
  .amdhsa_next_free_vgpr 128
  .amdhsa_next_free_sgpr 80
  .amdhsa_accum_offset 128
  .amdhsa_group_segment_fixed_size 0
  .amdhsa_kernarg_size 88
  .amdhsa_user_sgpr_count 2
  .amdhsa_user_sgpr_kernarg_segment_ptr 1
  .amdhsa_system_sgpr_workgroup_id_x 1
.end_amdhsa_kernel
.p2align 6
.amdhsa_kernel k2_kernel
  .amdhsa_next_free_vgpr 128
  .amdhsa_next_free_sgpr 80
  .amdhsa_accum_offset 128
  .amdhsa_group_segment_fixed_size 0
  .amdhsa_kernarg_size 88
  .amdhsa_user_sgpr_count 2
  .amdhsa_user_sgpr_kernarg_segment_ptr 1
  .amdhsa_system_sgpr_workgroup_id_x 1
.end_amdhsa_kernel
```
